```python
import torch

def _softmax(x, axis=-1):
    return torch.softmax(x, dim=axis)
def _gelu(x):
    return torch.nn.functional.gelu(x, approximate="tanh")
def _silu(x):
    return torch.nn.functional.silu(x)
def _sigmoid(x):
    return torch.sigmoid(x)
def _layernorm(x, axis=-1, eps=1e-5):
    m = x.mean(dim=axis, keepdim=True)
    v = x.var(dim=axis, keepdim=True, unbiased=False)
    return (x - m) / torch.sqrt(v + eps)
def _scatter_add(tgt, idx, src, axis=0):
    return tgt.clone().index_add_(axis, idx, src)
def _segment_sum(src, seg, n):
    out = torch.zeros((n,) + src.shape[1:], dtype=src.dtype)
    return out.index_add_(0, seg, src)
def _pad(x, pw):
    flat = tuple(v for pair in reversed(pw) for v in pair)
    return torch.nn.functional.pad(x, flat)

kernel_name = 'parallel_sum__linear_kernel_hedgehog__dense_activation_relu__prompt'

def setup_inputs():

    _w = (lambda a: (lambda t: t.to(torch.bfloat16) if t.is_floating_point() else t)(torch.as_tensor(a)))
    def _A_setup():
        B, S, D, H = 1, 2048, 512, 32
        Dh = D // H
        return {
            "x": _w((lambda *s: torch.randn(*s, dtype=torch.bfloat16) * 0.05)(B, S, D)),
            "wqkv": _w((lambda *s: torch.randn(*s, dtype=torch.bfloat16) * 0.4)(D, 3 * D)),
            "w_phi": _w((lambda *s: torch.randn(*s, dtype=torch.bfloat16) * 0.4)(H, Dh, Dh) * (Dh ** -0.5)),
            "wo": _w((lambda *s: torch.randn(*s, dtype=torch.bfloat16) * 0.1)(D, D)),
        }
    _A_in = _A_setup()

    def _B_setup():
        B, S, D, Dff = 1, 2048, 512, 1792
        return {
            "x": _w((lambda *s: torch.randn(*s, dtype=torch.bfloat16) * 0.05)(B, S, D)),
            "w1": _w((lambda *s: torch.randn(*s, dtype=torch.bfloat16) * 0.05)(D, Dff)),
            "w2": _w((lambda *s: torch.randn(*s, dtype=torch.bfloat16) * 0.05)(Dff, D)),
        }
    _B_in = _B_setup()

    return {
        "A_x": _A_in["x"],
        "A_wqkv": _A_in["wqkv"],
        "A_w_phi": _A_in["w_phi"],
        "A_wo": _A_in["wo"],
        "B_x": _B_in["x"],
        "B_w1": _B_in["w1"],
        "B_w2": _B_in["w2"],
    }

def reference(A_x, A_wqkv, A_w_phi, A_wo, B_x, B_w1, B_w2):
    def _A_ref(x, wqkv, w_phi, wo):
        B, S, D = x.shape
        H = 32; Dh = D // H
        qkv = (lambda x, *d: x.permute(*d))((x @ wqkv).reshape(B, S, 3, H, Dh), 2, 0, 3, 1, 4)
        q, k, v = qkv[0], qkv[1], qkv[2]
        pq = torch.einsum("bhsd,hdf->bhsf", q, w_phi)
        pk = torch.einsum("bhsd,hdf->bhsf", k, w_phi)
        phi_q = torch.concatenate([_softmax(pq, axis=-1), _softmax(-pq, axis=-1)], axis=-1)
        phi_k = torch.concatenate([_softmax(pk, axis=-1), _softmax(-pk, axis=-1)], axis=-1)
        kv = torch.einsum("bhsf,bhsd->bhfd", phi_k, v)
        z  = torch.einsum("bhsf->bhf", phi_k)
        num = torch.einsum("bhqf,bhfd->bhqd", phi_q, kv)
        den = torch.einsum("bhqf,bhf->bhq", phi_q, z)[..., None] + 1e-6
        o = num / den
        return (lambda x, *d: x.permute(*d))(o, 0, 2, 1, 3).reshape(B, S, D) @ wo

    def _B_ref(x, w1, w2):
        h = torch.einsum("bsd,df->bsf", x, w1)
        zero = torch.zeros_like(h)
        h = torch.maximum(h, zero)
        return torch.einsum("bsf,fd->bsd", h, w2)

    x = A_x
    xn = _layernorm(x, axis=-1)
    return x + _A_ref(xn, A_wqkv, A_w_phi, A_wo) + _B_ref(xn, B_w1, B_w2)
```

```asm
; @launch grid=(256,1,1) block=(512,1,1) lds=163840
.amdgcn_target "amdgcn-amd-amdhsa--gfx950"
.text
.globl parallel_sum__linear_kernel_hedgehog__dense_activation_relu__prompt_kernel
.p2align 8
.type parallel_sum__linear_kernel_hedgehog__dense_activation_relu__prompt_kernel,@function
parallel_sum__linear_kernel_hedgehog__dense_activation_relu__prompt_kernel:
    s_getpc_b64 s[4:5]
    v_lshlrev_b32 v2, 7, v0
    v_min_u32 v2, 0x81b0, v2
    global_load_dword v255, v2, s[4:5]
    s_load_dwordx2 s[24:25], s[0:1], 0
    s_load_dwordx2 s[28:29], s[0:1], 8
    s_load_dwordx2 s[72:73], s[0:1], 40
    s_load_dwordx2 s[44:45], s[0:1], 64
    s_load_dwordx2 s[40:41], s[0:1], 72
    s_load_dwordx2 s[52:53], s[0:1], 16
    s_load_dwordx2 s[32:33], s[0:1], 48
    s_load_dwordx2 s[36:37], s[0:1], 24
    s_load_dwordx2 s[48:49], s[0:1], 56
    s_cmp_ge_u32 s2, 256
    s_cbranch_scc1 L_END
    v_lshrrev_b32 v1, 6, v0
    v_and_b32 v0, 63, v0
    s_and_b32 s61, s2, 7
    v_readfirstlane_b32 s3, v1
    s_lshr_b32 s57, s2, 3
    s_bfe_u32 s64, s57, 0x10003
    s_lshr_b32 s65, s57, 4
    s_and_b32 s66, s64, s65
    s_lshl_b32 s56, s61, 1
    s_add_u32 s56, s56, s66
    s_lshl_b32 s58, s61, 2
    s_lshl_b32 s64, s64, 1
    s_add_u32 s58, s58, s64
    s_add_u32 s58, s58, s65
    s_and_b32 s59, s57, 7
    s_and_b32 s60, s3, 3
    s_mov_b32 s26, 0x200000
    s_mov_b32 s27, 0x20000
    s_mov_b32 s30, 0x180000
    s_mov_b32 s31, 0x20000
    s_mov_b32 s34, 0x1c0000
    s_mov_b32 s35, 0x20000
    s_mov_b32 s38, 0x80000
    s_mov_b32 s39, 0x20000
    s_mov_b32 s42, 0x10000000
    s_mov_b32 s43, 0x20000
    s_mov_b32 s46, 0x100
    s_mov_b32 s47, 0x20000
    s_mov_b32 s50, 0x200000
    s_mov_b32 s51, 0x20000
    s_mov_b32 s54, 0x4000
    s_mov_b32 s55, 0x20000
    s_mov_b32 s74, 0x1c0000
    s_mov_b32 s75, 0x20000
    s_cmp_lt_u32 s3, 4
    s_cbranch_scc1 L_C
    s_setprio 2
    s_and_b32 s68, s59, 1
    s_mul_i32 s67, s59, 448
    s_lshl_b32 s69, s68, 6
    s_add_u32 s69, s69, s67
    s_cmp_eq_u32 s68, 0
    s_cselect_b32 s68, 384, 0
    s_add_u32 s68, s68, s67
    s_lshl_b32 s67, s57, 6
    s_lshl_b32 s18, s60, 10
    s_lshl_b32 s19, s60, 12
    s_lshl_b32 s65, s60, 5
    s_cmp_lt_u32 s57, 16
    s_cselect_b32 s68, s67, s68
    s_movk_i32 s16, 3584
    s_cselect_b32 s16, 3072, s16
    s_cselect_b32 s67, 1, 0
    s_lshl_b32 s19, s19, s67
    s_lshl_b32 s65, s65, s67
    s_lshl_b32 s67, s67, 13
    s_sub_u32 s18, s18, s67
    s_add_u32 s18, s18, 40960
    s_lshl_b32 s14, s16, 6
    s_mov_b32 s13, 4096
    s_lshl_b32 s20, s60, 11
    s_add_u32 s20, s20, 16384
    v_lshrrev_b32 v9, 3, v0
    v_and_b32 v10, 7, v0
    v_lshrrev_b32 v11, 4, v0
    s_lshl_b32 s64, s56, 7
    s_add_u32 s65, s64, s65
    v_add_u32 v1, s65, v9
    v_lshlrev_b32 v1, 10, v1
    v_xor_b32 v12, v10, v11
    v_lshl_or_b32 v1, v12, 4, v1
    v_xor_b32 v2, 64, v1
    v_add_u32 v2, 7168, v2
    v_add_u32 v3, 14336, v1
    v_add_u32 v4, 14336, v2
    s_lshl_b32 s65, s60, 4
    v_lshrrev_b32 v12, 2, v0
    v_add_u32 v12, s65, v12
    v_mul_u32_u24 v7, s16, v12
    v_lshrrev_b32 v12, 5, v0
    v_lshlrev_b32 v13, 1, v12
    v_and_b32 v12, 3, v0
    v_xor_b32 v13, v13, v12
    v_lshl_add_u32 v7, v13, 4, v7
    v_add_u32 v7, s68, v7
    v_add_u32 v12, s65, v9
    v_mul_u32_u24 v5, 3584, v12
    v_and_b32 v11, 1, v11
    v_lshlrev_b32 v11, 1, v11
    v_xor_b32 v11, v11, v10
    v_lshl_add_u32 v5, v11, 4, v5
    v_add_u32 v5, s69, v5
    v_xor_b32 v6, 64, v5
    v_add_u32 v6, 27648, v6
    s_mov_b32 s12, s61
    s_mov_b32 s79, 0x20000
    s_waitcnt lgkmcnt(0)
    s_cmp_lt_u32 s57, 16
    s_cselect_b32 s76, s28, s72
    s_cselect_b32 s77, s29, s73
    s_cselect_b32 s78, s30, s74
    s_call_b64 s[6:7], L_ISSUE
    s_branch L_LMAIN
L_ISSUE:
    s_lshl_b32 s64, s12, 7
    s_mul_i32 s65, s12, s14
    s_add_u32 m0, s13, s19
    s_add_u32 s12, s12, 1
    buffer_load_dwordx4 v1, s[24:27], s64 offen lds
    buffer_load_dwordx4 v2, s[24:27], s64 offen offset:1024 lds
    buffer_load_dwordx4 v3, s[24:27], s64 offen offset:2048 lds
    buffer_load_dwordx4 v4, s[24:27], s64 offen offset:3072 lds
    s_and_b32 s12, s12, 7
    s_cmp_lt_u32 s57, 16
    s_cbranch_scc1 L_ISA
    s_add_u32 m0, s13, s20
    s_nop 0
    buffer_load_dwordx4 v5, s[76:79], s65 offen lds
    buffer_load_dwordx4 v6, s[76:79], s65 offen offset:1024 lds
    s_add_u32 m0, m0, 8064
    s_nop 0
    buffer_load_dwordx4 v5, s[76:79], s65 offen offset:128 lds
    buffer_load_dwordx4 v6, s[76:79], s65 offen offset:1152 lds
    s_add_u32 m0, m0, 8064
    s_nop 0
    buffer_load_dwordx4 v5, s[76:79], s65 offen offset:256 lds
    buffer_load_dwordx4 v6, s[76:79], s65 offen offset:1280 lds
    s_add_u32 m0, s13, s18
    s_branch L_ISE
L_ISA:
    s_add_u32 m0, m0, 4096
    s_add_u32 s64, s64, 32768
    buffer_load_dwordx4 v1, s[24:27], s64 offen lds
    buffer_load_dwordx4 v2, s[24:27], s64 offen offset:1024 lds
    buffer_load_dwordx4 v3, s[24:27], s64 offen offset:2048 lds
    buffer_load_dwordx4 v4, s[24:27], s64 offen offset:3072 lds
    s_add_u32 m0, s13, s18
    s_add_u32 m0, m0, 3072
    s_nop 0
    buffer_load_dwordx4 v7, s[76:79], s65 offen offset:1024 lds
    s_add_u32 m0, m0, 3072
    s_nop 0
    buffer_load_dwordx4 v7, s[76:79], s65 offen offset:2048 lds
    s_sub_u32 m0, m0, 6144
L_ISE:
    s_add_u32 s13, s13, 45056
    buffer_load_dwordx4 v7, s[76:79], s65 offen lds
    s_cmp_eq_u32 s13, 139264
    s_cselect_b32 s13, 4096, s13
    s_setpc_b64 s[6:7]
L_LMAIN:
    v_lshrrev_b32 v76, 4, v0
    v_lshlrev_b32 v72, 10, v76
    v_and_b32 v76, 1, v76
    v_lshl_or_b32 v72, v76, 6, v72
    v_bfe_u32 v76, v0, 2, 2
    v_lshl_or_b32 v72, v76, 7, v72
    v_bfe_u32 v76, v0, 3, 1
    v_lshl_or_b32 v72, v76, 5, v72
    v_and_b32 v76, 3, v0
    v_lshl_or_b32 v72, v76, 3, v72
    v_lshrrev_b32 v76, 4, v0
    v_lshlrev_b32 v73, 9, v76
    v_and_b32 v76, 1, v76
    v_lshl_or_b32 v73, v76, 5, v73
    v_bfe_u32 v76, v0, 2, 2
    v_lshl_or_b32 v73, v76, 6, v73
    v_and_b32 v76, 3, v0
    v_lshl_or_b32 v73, v76, 3, v73
    v_lshlrev_b32 v64, 3, v0
    s_mov_b32 s4, 1
    s_mov_b32 s5, 0
    s_cmp_lt_u32 s57, 16
    s_cbranch_scc1 L_CSA
    s_mov_b32 s5, 1
    s_cmp_eq_u32 s60, 3
    s_cbranch_scc1 L_CSH
    s_mov_b32 s4, 3
    s_lshl_b32 s64, s60, 13
    s_add_u32 s64, s64, 20480
    v_add_u32 v72, s64, v72
    v_xor_b32 v73, 32, v72
    v_xor_b32 v74, 64, v72
    v_xor_b32 v75, 0x60, v72
    s_movk_i32 s64, 512
    s_branch L_CSE
L_CSH:
    s_mov_b32 s64, 45056
    s_branch L_CSB
L_CSA:
    s_min_u32 s64, s60, 2
    s_lshl_b32 s64, s64, 12
    s_add_u32 s64, s64, 36864
L_CSB:
    v_add_u32 v72, s64, v73
    v_xor_b32 v73, 32, v72
    v_add_u32 v74, 2048, v72
    v_add_u32 v75, 2048, v73
    s_movk_i32 s64, 256
L_CSE:
    v_add_u32 v76, s64, v72
    v_add_u32 v77, s64, v73
    v_add_u32 v78, s64, v74
    v_add_u32 v79, s64, v75
    v_bfe_u32 v48, v0, 2, 2
    v_mov_b32 v49, 0x3f803f80
    s_and_b32 s64, s4, 0
    v_cmp_eq_u32 vcc, s64, v48
    s_nop 1
    v_cndmask_b32 v96, 0, v49, vcc
    v_mov_b32 v97, v96
    v_mov_b32 v98, v96
    v_mov_b32 v99, v96
    s_and_b32 s64, s4, 1
    v_cmp_eq_u32 vcc, s64, v48
    s_nop 1
    v_cndmask_b32 v100, 0, v49, vcc
    v_mov_b32 v101, v100
    v_mov_b32 v102, v100
    v_mov_b32 v103, v100
    s_and_b32 s64, s4, 2
    v_cmp_eq_u32 vcc, s64, v48
    s_nop 1
    v_cndmask_b32 v104, 0, v49, vcc
    v_mov_b32 v105, v104
    v_mov_b32 v106, v104
    v_mov_b32 v107, v104
    s_and_b32 s64, s4, 3
    v_cmp_eq_u32 vcc, s64, v48
    s_nop 1
    v_cndmask_b32 v108, 0, v49, vcc
    v_mov_b32 v109, v108
    v_mov_b32 v110, v108
    v_mov_b32 v111, v108
    v_lshrrev_b32 v56, 5, v0
    s_lshl_b32 s64, s60, 4
    v_lshl_add_u32 v56, v56, 3, s64
    v_mov_b32 v53, 0
    v_mov_b32 v60, 1
    v_mov_b32 v48, 0
    v_mov_b32 v49, 0
    v_mov_b32 v50, 0
    v_mov_b32 v51, 0
    s_lshl_b32 s64, s60, 2
    v_mov_b32 v66, s64
    v_mov_b32 v67, s5
    ds_write_b32 v53, v60 offset:4
    ds_write_b128 v53, v[48:51] offset:16
    ds_write_b64 v53, v[48:49] offset:8
    ds_write_b128 v53, v[48:51] offset:48
    ds_write_b128 v53, v[48:51] offset:128
    ds_write_b32 v66, v67 offset:32
    s_call_b64 s[6:7], L_ISSUE
    buffer_load_dword v52, v53, s[44:47], 0 offen sc1
    s_lshl_b32 s21, s60, 12
    s_add_u32 s21, s21, 94208
    v_lshrrev_b32 v12, 3, v0
    v_lshlrev_b32 v8, 10, v12
    v_and_b32 v12, 7, v0
    v_lshrrev_b32 v13, 4, v0
    v_lshlrev_b32 v13, 1, v13
    v_xor_b32 v12, v12, v13
    v_lshl_or_b32 v8, v12, 4, v8
    s_lshl_b32 s64, s59, 7
    v_add_u32 v8, s64, v8
    v_add_u32 v9, 7168, v8
    v_add_u32 v10, 14336, v8
    v_add_u32 v11, 21504, v8
    v_lshrrev_b32 v13, 2, v0
    v_lshlrev_b32 v12, 7, v13
    v_bfe_u32 v13, v0, 3, 2
    v_lshl_or_b32 v12, v13, 5, v12
    v_and_b32 v13, 3, v0
    v_lshl_or_b32 v12, v13, 3, v12
    v_add_u32 v12, s21, v12
    v_xor_b32 v13, 32, v12
    v_xor_b32 v14, 64, v12
    v_xor_b32 v15, 96, v12
    s_mul_i32 s23, s60, 9
    s_mul_i32 s64, s60, 5
    s_add_u32 s64, s64, 36
    s_cmp_lt_u32 s57, 16
    s_cselect_b32 s23, s64, s23
    s_lshl_b32 s22, s60, 2
    s_waitcnt vmcnt(12)
    s_waitcnt lgkmcnt(0)
    s_barrier
    s_call_b64 s[6:7], L_ISSUE
    ds_read_b64 v[60:61], v56 offset:64
    ds_read_b64_tr_b16 v[16:17], v72 offset:0
    ds_read_b64_tr_b16 v[18:19], v76 offset:0
    ds_read_b64_tr_b16 v[20:21], v73 offset:0
    ds_read_b64_tr_b16 v[22:23], v77 offset:0
    ds_read_b64_tr_b16 v[24:25], v74 offset:0
    ds_read_b64_tr_b16 v[26:27], v78 offset:0
    ds_read_b64_tr_b16 v[28:29], v75 offset:0
    ds_read_b64_tr_b16 v[30:31], v79 offset:0
    s_cmp_eq_u32 s4, 1
    s_cbranch_scc1 CSH_1
    ds_read_b64_tr_b16 v[32:33], v72 offset:4096
    ds_read_b64_tr_b16 v[34:35], v76 offset:4096
    ds_read_b64_tr_b16 v[36:37], v73 offset:4096
    ds_read_b64_tr_b16 v[38:39], v77 offset:4096
    ds_read_b64_tr_b16 v[40:41], v74 offset:4096
    ds_read_b64_tr_b16 v[42:43], v78 offset:4096
    ds_read_b64_tr_b16 v[44:45], v75 offset:4096
    ds_read_b64_tr_b16 v[46:47], v79 offset:4096
    s_waitcnt lgkmcnt(0)
    v_mfma_f32_16x16x32_bf16 v[48:51], v[96:99], v[32:35], v[48:51]
    v_mfma_f32_16x16x32_bf16 v[48:51], v[100:103], v[36:39], v[48:51]
    v_mfma_f32_16x16x32_bf16 v[48:51], v[104:107], v[40:43], v[48:51]
    v_mfma_f32_16x16x32_bf16 v[48:51], v[108:111], v[44:47], v[48:51]
CSH_1:
    s_waitcnt lgkmcnt(0)
    v_mfma_f32_16x16x32_bf16 v[48:51], v[96:99], v[16:19], v[48:51]
    v_mfma_f32_16x16x32_bf16 v[48:51], v[100:103], v[20:23], v[48:51]
    v_mfma_f32_16x16x32_bf16 v[48:51], v[104:107], v[24:27], v[48:51]
    v_mfma_f32_16x16x32_bf16 v[48:51], v[108:111], v[28:31], v[48:51]
    s_add_u32 s64, s59, 16
    s_cmp_lt_u32 s57, 16
    s_cselect_b32 s64, s57, s64
    s_lshl_b32 s17, s64, 15
    s_lshl_b32 s64, s60, 9
    s_add_u32 s17, s17, s64
    s_add_u32 s17, s17, 10027008
    s_lshl_b32 s64, s56, 11
    s_add_u32 s16, s17, s64
    s_getreg_b32 s15, hwreg(HW_REG_XCC_ID)
    v_mov_b32 v62, s15
    s_lshl_b32 s64, s61, 8
    s_lshl_b32 s65, s57, 3
    s_add_u32 s65, s65, s64
    s_lshl_b32 s66, s60, 1
    s_add_u32 s65, s65, s66
    s_lshl_b32 s65, s65, 4
    s_add_u32 s65, s65, 9437184
    v_lshrrev_b32 v55, 5, v0
    v_lshl_add_u32 v55, v55, 4, s65
    s_lshl_b32 s66, s60, 6
    s_add_u32 s64, s64, s66
    s_lshl_b32 s64, s64, 4
    s_add_u32 s64, s64, 9437184
    v_lshl_add_u32 v54, v0, 4, s64
    s_waitcnt vmcnt(11)
    v_readfirstlane_b32 s62, v52
    s_nop 0
    s_cmp_eq_u32 s62, 0
    s_cbranch_scc1 L_NP1
    v_mov_b32 v63, s62
    s_mov_b32 exec_lo, 1
    s_mov_b32 exec_hi, 1
    buffer_store_dwordx4 v[60:63], v55, s[40:43], 0 offen sc1
    s_mov_b64 exec, -1
L_NP1:
    s_waitcnt lgkmcnt(0)
    s_barrier
    s_call_b64 s[6:7], L_ISSUE
    ds_read_b64_tr_b16 v[16:17], v72 offset:45056
    ds_read_b64_tr_b16 v[18:19], v76 offset:45056
    ds_read_b64_tr_b16 v[20:21], v73 offset:45056
    ds_read_b64_tr_b16 v[22:23], v77 offset:45056
    ds_read_b64_tr_b16 v[24:25], v74 offset:45056
    ds_read_b64_tr_b16 v[26:27], v78 offset:45056
    ds_read_b64_tr_b16 v[28:29], v75 offset:45056
    ds_read_b64_tr_b16 v[30:31], v79 offset:45056
    s_cmp_eq_u32 s4, 1
    s_cbranch_scc1 CSH_2
    ds_read_b64_tr_b16 v[32:33], v72 offset:49152
    ds_read_b64_tr_b16 v[34:35], v76 offset:49152
    ds_read_b64_tr_b16 v[36:37], v73 offset:49152
    ds_read_b64_tr_b16 v[38:39], v77 offset:49152
    ds_read_b64_tr_b16 v[40:41], v74 offset:49152
    ds_read_b64_tr_b16 v[42:43], v78 offset:49152
    ds_read_b64_tr_b16 v[44:45], v75 offset:49152
    ds_read_b64_tr_b16 v[46:47], v79 offset:49152
    s_waitcnt lgkmcnt(0)
    v_mfma_f32_16x16x32_bf16 v[48:51], v[96:99], v[32:35], v[48:51]
    v_mfma_f32_16x16x32_bf16 v[48:51], v[100:103], v[36:39], v[48:51]
    v_mfma_f32_16x16x32_bf16 v[48:51], v[104:107], v[40:43], v[48:51]
    v_mfma_f32_16x16x32_bf16 v[48:51], v[108:111], v[44:47], v[48:51]
CSH_2:
    s_waitcnt lgkmcnt(0)
    v_mfma_f32_16x16x32_bf16 v[48:51], v[96:99], v[16:19], v[48:51]
    v_mfma_f32_16x16x32_bf16 v[48:51], v[100:103], v[20:23], v[48:51]
    v_mfma_f32_16x16x32_bf16 v[48:51], v[104:107], v[24:27], v[48:51]
    v_mfma_f32_16x16x32_bf16 v[48:51], v[108:111], v[28:31], v[48:51]
    s_cmp_lg_u32 s62, 0
    s_cbranch_scc1 L_NP2
    s_mov_b32 s70, 40000
EP_3:
    buffer_load_dword v52, v53, s[44:47], 0 offen sc1
    s_waitcnt vmcnt(0)
    v_readfirstlane_b32 s62, v52
    s_nop 0
    s_cmp_lg_u32 s62, 0
    s_cbranch_scc1 EPD_4
    s_sub_u32 s70, s70, 1
    s_cbranch_scc1 EPD_4
    s_sleep 1
    s_branch EP_3
EPD_4:
    v_mov_b32 v63, s62
    s_mov_b32 exec_lo, 1
    s_mov_b32 exec_hi, 1
    buffer_store_dwordx4 v[60:63], v55, s[40:43], 0 offen sc1
    s_mov_b64 exec, -1
L_NP2:
    v_mov_b32 v49, s62
    buffer_store_dwordx2 v[48:49], v64, s[40:43], s16 offen sc1
    s_cmp_lt_u32 s57, 16
    s_cbranch_scc1 L_LATT
    s_waitcnt vmcnt(12)
    s_waitcnt lgkmcnt(0)
    s_barrier
    s_call_b64 s[6:7], L_ISSUE
    s_lshl_b32 s64, s57, 2
    s_add_u32 s64, s64, s60
    s_sub_u32 s64, s64, 64
    v_lshlrev_b32 v69, 10, v0
    v_add_u32 v69, 384, v69
    s_mul_i32 s65, s64, 28672
    s_mov_b64 exec, 0xfffffff
    buffer_load_dword v68, v69, s[32:35], s65 offen
    s_lshl_b32 s65, s64, 13
    s_mov_b64 exec, 0xff
    buffer_load_dword v68, v69, s[36:39], s65 offen
    s_mov_b64 exec, -1
    s_waitcnt vmcnt(14)
    s_waitcnt lgkmcnt(0)
    s_barrier
    s_call_b64 s[6:7], L_ISSUE
    buffer_load_dwordx4 v[56:59], v54, s[40:43], 0 offen
    s_add_u32 s64, s56, 4
    s_and_b32 s64, s64, 15
    s_lshl_b32 s64, s64, 11
    s_add_u32 s64, s64, s17
    buffer_load_dwordx2 v[80:81], v64, s[40:43], s64 offen
    s_add_u32 s64, s56, 8
    s_and_b32 s64, s64, 15
    s_lshl_b32 s64, s64, 11
    s_add_u32 s64, s64, s17
    buffer_load_dwordx2 v[82:83], v64, s[40:43], s64 offen
    s_add_u32 s64, s56, 12
    s_and_b32 s64, s64, 15
    s_lshl_b32 s64, s64, 11
    s_add_u32 s64, s64, s17
    buffer_load_dwordx2 v[84:85], v64, s[40:43], s64 offen
    s_waitcnt vmcnt(17)
    s_waitcnt lgkmcnt(0)
    s_barrier
    s_call_b64 s[6:7], L_ISSUE
    s_add_u32 m0, s21, 0xc000
    s_add_u32 s64, s23, 0
    s_lshl_b32 s64, s64, 15
    buffer_load_dwordx4 v8, s[32:35], s64 offen offset:0 lds
    buffer_load_dwordx4 v9, s[32:35], s64 offen offset:1024 lds
    buffer_load_dwordx4 v10, s[32:35], s64 offen offset:2048 lds
    buffer_load_dwordx4 v11, s[32:35], s64 offen offset:3072 lds
    s_waitcnt vmcnt(19)
    s_waitcnt lgkmcnt(0)
    s_barrier
    s_call_b64 s[6:7], L_ISSUE
    s_waitcnt vmcnt(11)
    ds_read_b64_tr_b16 v[112:113], v12 offset:49152
    ds_read_b64_tr_b16 v[114:115], v12 offset:51200
    ds_read_b64_tr_b16 v[116:117], v13 offset:49152
    ds_read_b64_tr_b16 v[118:119], v13 offset:51200
    ds_read_b64_tr_b16 v[120:121], v14 offset:49152
    ds_read_b64_tr_b16 v[122:123], v14 offset:51200
    ds_read_b64_tr_b16 v[124:125], v15 offset:49152
    ds_read_b64_tr_b16 v[126:127], v15 offset:51200
    s_waitcnt lgkmcnt(0)
    s_add_u32 m0, s21, 0xc000
    s_add_u32 s64, s23, 1
    s_lshl_b32 s64, s64, 15
    buffer_load_dwordx4 v8, s[32:35], s64 offen offset:0 lds
    buffer_load_dwordx4 v9, s[32:35], s64 offen offset:1024 lds
    buffer_load_dwordx4 v10, s[32:35], s64 offen offset:2048 lds
    buffer_load_dwordx4 v11, s[32:35], s64 offen offset:3072 lds
    s_waitcnt lgkmcnt(0)
    s_barrier
    s_mov_b32 s70, 40000
GC_5:
    v_max_u32 v66, v59, v81
    v_min_u32 v67, v59, v81
    v_max3_u32 v66, v66, v83, v85
    v_min3_u32 v67, v67, v83, v85
    v_cmp_eq_u32 vcc, s62, v66
    s_nop 0
    s_mov_b64 s[64:65], vcc
    v_cmp_eq_u32 vcc, s62, v67
    s_nop 0
    s_and_b64 s[64:65], s[64:65], vcc
    s_cmp_eq_u64 s[64:65], -1
    s_cbranch_scc1 GCD_6
    s_sub_u32 s70, s70, 1
    s_cbranch_scc1 GCD_6
    s_sleep 1
    buffer_load_dwordx4 v[56:59], v54, s[40:43], 0 offen sc1
    s_add_u32 s64, s56, 4
    s_and_b32 s64, s64, 15
    s_lshl_b32 s64, s64, 11
    s_add_u32 s64, s64, s17
    buffer_load_dwordx2 v[80:81], v64, s[40:43], s64 offen sc1
    s_add_u32 s64, s56, 8
    s_and_b32 s64, s64, 15
    s_lshl_b32 s64, s64, 11
    s_add_u32 s64, s64, s17
    buffer_load_dwordx2 v[82:83], v64, s[40:43], s64 offen sc1
    s_add_u32 s64, s56, 12
    s_and_b32 s64, s64, 15
    s_lshl_b32 s64, s64, 11
    s_add_u32 s64, s64, s17
    buffer_load_dwordx2 v[84:85], v64, s[40:43], s64 offen sc1
    s_waitcnt vmcnt(0)
    s_branch GC_5
GCD_6:
    v_add_f32 v48, v48, v80
    v_add_f32 v48, v48, v82
    v_add_f32 v48, v48, v84
    s_lshl_b32 s64, s60, 8
    v_lshl_add_u32 v66, v0, 2, s64
    ds_write_b32 v66, v48 offset:3072
    ds_write_b32 v66, v56 offset:1024
    ds_write_b32 v66, v57 offset:2048
    v_cmp_eq_u32 vcc, s15, v58
    s_nop 0
    s_cmp_eq_u64 vcc, -1
    s_cselect_b32 s63, 1, 0
    v_mov_b32 v60, s62
    v_mov_b32 v61, s63
    v_mov_b32 v55, 0
    s_mov_b64 exec, 1
    ds_write_b32 v55, v60 offset:0
    ds_min_u32 v55, v61 offset:4
    s_mov_b64 exec, -1
    s_waitcnt vmcnt(0)
    ds_read_b64_tr_b16 v[128:129], v12 offset:49152
    ds_read_b64_tr_b16 v[130:131], v12 offset:51200
    ds_read_b64_tr_b16 v[132:133], v13 offset:49152
    ds_read_b64_tr_b16 v[134:135], v13 offset:51200
    ds_read_b64_tr_b16 v[136:137], v14 offset:49152
    ds_read_b64_tr_b16 v[138:139], v14 offset:51200
    ds_read_b64_tr_b16 v[140:141], v15 offset:49152
    ds_read_b64_tr_b16 v[142:143], v15 offset:51200
    s_waitcnt lgkmcnt(0)
    s_add_u32 m0, s21, 0x0
    s_add_u32 s64, s23, 2
    s_lshl_b32 s64, s64, 15
    buffer_load_dwordx4 v8, s[32:35], s64 offen offset:0 lds
    buffer_load_dwordx4 v9, s[32:35], s64 offen offset:1024 lds
    buffer_load_dwordx4 v10, s[32:35], s64 offen offset:2048 lds
    buffer_load_dwordx4 v11, s[32:35], s64 offen offset:3072 lds
    s_add_u32 m0, s21, 0x4000
    s_add_u32 s64, s23, 3
    s_lshl_b32 s64, s64, 15
    buffer_load_dwordx4 v8, s[32:35], s64 offen offset:0 lds
    buffer_load_dwordx4 v9, s[32:35], s64 offen offset:1024 lds
    buffer_load_dwordx4 v10, s[32:35], s64 offen offset:2048 lds
    buffer_load_dwordx4 v11, s[32:35], s64 offen offset:3072 lds
    s_add_u32 m0, s21, 0x8000
    s_add_u32 s64, s23, 4
    s_lshl_b32 s64, s64, 15
    buffer_load_dwordx4 v8, s[32:35], s64 offen offset:0 lds
    buffer_load_dwordx4 v9, s[32:35], s64 offen offset:1024 lds
    buffer_load_dwordx4 v10, s[32:35], s64 offen offset:2048 lds
    buffer_load_dwordx4 v11, s[32:35], s64 offen offset:3072 lds
    s_waitcnt lgkmcnt(0)
    s_barrier
    s_add_u32 m0, s21, 0xc000
    s_add_u32 s64, s23, 5
    s_lshl_b32 s64, s64, 15
    buffer_load_dwordx4 v8, s[32:35], s64 offen offset:0 lds
    buffer_load_dwordx4 v9, s[32:35], s64 offen offset:1024 lds
    buffer_load_dwordx4 v10, s[32:35], s64 offen offset:2048 lds
    buffer_load_dwordx4 v11, s[32:35], s64 offen offset:3072 lds
    s_waitcnt vmcnt(12)
    ds_read_b64_tr_b16 v[144:145], v12 offset:0
    ds_read_b64_tr_b16 v[146:147], v12 offset:2048
    ds_read_b64_tr_b16 v[148:149], v13 offset:0
    ds_read_b64_tr_b16 v[150:151], v13 offset:2048
    ds_read_b64_tr_b16 v[152:153], v14 offset:0
    ds_read_b64_tr_b16 v[154:155], v14 offset:2048
    ds_read_b64_tr_b16 v[156:157], v15 offset:0
    ds_read_b64_tr_b16 v[158:159], v15 offset:2048
    s_waitcnt lgkmcnt(0)
    s_add_u32 m0, s21, 0x0
    s_add_u32 s64, s23, 6
    s_lshl_b32 s64, s64, 15
    buffer_load_dwordx4 v8, s[32:35], s64 offen offset:0 lds
    buffer_load_dwordx4 v9, s[32:35], s64 offen offset:1024 lds
    buffer_load_dwordx4 v10, s[32:35], s64 offen offset:2048 lds
    buffer_load_dwordx4 v11, s[32:35], s64 offen offset:3072 lds
    s_waitcnt vmcnt(12)
    ds_read_b64_tr_b16 v[160:161], v12 offset:16384
    ds_read_b64_tr_b16 v[162:163], v12 offset:18432
    ds_read_b64_tr_b16 v[164:165], v13 offset:16384
    ds_read_b64_tr_b16 v[166:167], v13 offset:18432
    ds_read_b64_tr_b16 v[168:169], v14 offset:16384
    ds_read_b64_tr_b16 v[170:171], v14 offset:18432
    ds_read_b64_tr_b16 v[172:173], v15 offset:16384
    ds_read_b64_tr_b16 v[174:175], v15 offset:18432
    s_waitcnt lgkmcnt(0)
    s_add_u32 m0, s21, 0x4000
    s_add_u32 s64, s23, 7
    s_lshl_b32 s64, s64, 15
    buffer_load_dwordx4 v8, s[32:35], s64 offen offset:0 lds
    buffer_load_dwordx4 v9, s[32:35], s64 offen offset:1024 lds
    buffer_load_dwordx4 v10, s[32:35], s64 offen offset:2048 lds
    buffer_load_dwordx4 v11, s[32:35], s64 offen offset:3072 lds
    s_waitcnt vmcnt(12)
    ds_read_b64_tr_b16 v[176:177], v12 offset:32768
    ds_read_b64_tr_b16 v[178:179], v12 offset:34816
    ds_read_b64_tr_b16 v[180:181], v13 offset:32768
    ds_read_b64_tr_b16 v[182:183], v13 offset:34816
    ds_read_b64_tr_b16 v[184:185], v14 offset:32768
    ds_read_b64_tr_b16 v[186:187], v14 offset:34816
    ds_read_b64_tr_b16 v[188:189], v15 offset:32768
    ds_read_b64_tr_b16 v[190:191], v15 offset:34816
    s_waitcnt lgkmcnt(0)
    s_add_u32 m0, s21, 0x8000
    s_add_u32 s64, s23, 8
    s_lshl_b32 s64, s64, 15
    buffer_load_dwordx4 v8, s[32:35], s64 offen offset:0 lds
    buffer_load_dwordx4 v9, s[32:35], s64 offen offset:1024 lds
    buffer_load_dwordx4 v10, s[32:35], s64 offen offset:2048 lds
    buffer_load_dwordx4 v11, s[32:35], s64 offen offset:3072 lds
    s_waitcnt vmcnt(12)
    ds_read_b64_tr_b16 v[192:193], v12 offset:49152
    ds_read_b64_tr_b16 v[194:195], v12 offset:51200
    ds_read_b64_tr_b16 v[196:197], v13 offset:49152
    ds_read_b64_tr_b16 v[198:199], v13 offset:51200
    ds_read_b64_tr_b16 v[200:201], v14 offset:49152
    ds_read_b64_tr_b16 v[202:203], v14 offset:51200
    ds_read_b64_tr_b16 v[204:205], v15 offset:49152
    ds_read_b64_tr_b16 v[206:207], v15 offset:51200
    s_waitcnt vmcnt(8)
    ds_read_b64_tr_b16 v[208:209], v12 offset:0
    ds_read_b64_tr_b16 v[210:211], v12 offset:2048
    ds_read_b64_tr_b16 v[212:213], v13 offset:0
    ds_read_b64_tr_b16 v[214:215], v13 offset:2048
    ds_read_b64_tr_b16 v[216:217], v14 offset:0
    ds_read_b64_tr_b16 v[218:219], v14 offset:2048
    ds_read_b64_tr_b16 v[220:221], v15 offset:0
    ds_read_b64_tr_b16 v[222:223], v15 offset:2048
    s_waitcnt vmcnt(4)
    ds_read_b64_tr_b16 v[224:225], v12 offset:16384
    ds_read_b64_tr_b16 v[226:227], v12 offset:18432
    ds_read_b64_tr_b16 v[228:229], v13 offset:16384
    ds_read_b64_tr_b16 v[230:231], v13 offset:18432
    ds_read_b64_tr_b16 v[232:233], v14 offset:16384
    ds_read_b64_tr_b16 v[234:235], v14 offset:18432
    ds_read_b64_tr_b16 v[236:237], v15 offset:16384
    ds_read_b64_tr_b16 v[238:239], v15 offset:18432
    s_waitcnt vmcnt(0)
    ds_read_b64_tr_b16 v[240:241], v12 offset:32768
    ds_read_b64_tr_b16 v[242:243], v12 offset:34816
    ds_read_b64_tr_b16 v[244:245], v13 offset:32768
    ds_read_b64_tr_b16 v[246:247], v13 offset:34816
    ds_read_b64_tr_b16 v[248:249], v14 offset:32768
    ds_read_b64_tr_b16 v[250:251], v14 offset:34816
    ds_read_b64_tr_b16 v[252:253], v15 offset:32768
    ds_read_b64_tr_b16 v[254:255], v15 offset:34816
    s_waitcnt lgkmcnt(0)
    v_lshlrev_b32 v3, 2, v0
    s_lshr_b32 s69, s58, 1
    s_lshl_b32 s69, s69, 8
    s_add_u32 s69, s69, 0x909000
    s_lshl_b32 s64, s60, 3
    s_lshr_b32 s65, 0xc080808, s64
    s_lshr_b32 s66, 0xc080400, s64
    s_bfm_b32 s67, s65, s66
    buffer_load_dword v4, v3, s[40:43], s69 offen sc1
    s_lshl_b32 s64, s58, 6
    s_lshl_b32 s65, s60, 4
    s_add_u32 s64, s64, s65
    s_lshl_b32 s64, s64, 10
    s_lshl_b32 s65, s59, 7
    s_add_u32 s64, s64, s65
    v_and_b32 v5, 15, v0
    v_lshlrev_b32 v5, 10, v5
    v_and_b32 v12, 48, v0
    v_add3_u32 v5, v5, v12, s64
    v_lshlrev_b32 v1, 4, v0
    s_mul_i32 s19, s58, 288
    s_add_u32 s19, s19, s23
    s_add_u32 s19, s19, 0
    s_lshl_b32 s19, s19, 10
    s_xor_b32 s64, s58, 1
    s_mul_i32 s68, s64, 288
    s_add_u32 s68, s68, s23
    s_lshl_b32 s68, s68, 10
    s_lshl_b32 s16, s64, 3
    s_add_u32 s16, s16, s59
    s_lshl_b32 s16, s16, 14
    s_lshl_b32 s65, s60, 12
    s_add_u32 s16, s16, s65
    s_add_u32 s16, s16, 11534336
    s_and_b32 s64, s64, 1
    s_lshl_b32 s64, s64, 5
    s_lshl_b32 s65, s59, 2
    s_add_u32 s64, s64, s65
    s_add_u32 s64, s64, s60
    s_lshl_b32 s64, s64, 2
    s_lshr_b32 s65, s58, 1
    s_lshl_b32 s65, s65, 8
    s_add_u32 s17, s64, s65
    s_add_u32 s17, s17, 9478144
    s_lshl_b32 s64, s60, 14
    s_add_u32 s64, s64, 94208
    v_add_u32 v96, s64, v1
    s_and_b32 s64, s58, 1
    s_lshl_b32 s64, s64, 5
    s_lshl_b32 s65, s59, 2
    s_add_u32 s64, s64, s65
    s_mov_b32 s65, s60
    s_add_u32 s64, s64, s65
    s_lshl_b32 s64, s64, 2
    s_lshr_b32 s66, s58, 1
    s_lshl_b32 s66, s66, 8
    s_add_u32 s10, s64, s66
    s_add_u32 s10, s10, 9478144
    s_lshl_b32 s11, s58, 3
    s_add_u32 s11, s11, s59
    s_lshl_b32 s11, s11, 14
    s_lshl_b32 s65, s65, 12
    s_add_u32 s11, s11, s65
    s_add_u32 s11, s11, 11534336
    v_mov_b32 v6, 0
    v_add_u32 v2, s21, v1
    s_mov_b32 s70, 40000
    s_waitcnt vmcnt(0)
    s_branch FPC_9
FP_7:
    buffer_load_dword v4, v3, s[40:43], s69 offen sc1
    s_waitcnt vmcnt(0)
FPC_9:
    v_cmp_eq_u32 vcc, s62, v4
    s_nop 0
    s_and_b32 s71, vcc_hi, s67
    s_cmp_eq_u32 s71, s67
    s_cbranch_scc1 FPD_8
    s_sub_u32 s70, s70, 1
    s_cbranch_scc1 FPD_8
    s_sleep 1
    s_branch FP_7
FPD_8:
    s_add_u32 s64, s68, 0
    buffer_load_dwordx4 v[16:19], v1, s[40:43], s64 offen offset:0 sc1
    s_add_u32 s64, s68, 0
    buffer_load_dwordx4 v[20:23], v1, s[40:43], s64 offen offset:1024 sc1
    s_add_u32 s64, s68, 0
    buffer_load_dwordx4 v[24:27], v1, s[40:43], s64 offen offset:2048 sc1
    s_add_u32 s64, s68, 0
    buffer_load_dwordx4 v[28:31], v1, s[40:43], s64 offen offset:3072 sc1
    s_add_u32 s64, s68, 4096
    buffer_load_dwordx4 v[32:35], v1, s[40:43], s64 offen offset:0 sc1
    s_add_u32 s64, s68, 4096
    buffer_load_dwordx4 v[36:39], v1, s[40:43], s64 offen offset:1024 sc1
    s_add_u32 s64, s68, 4096
    buffer_load_dwordx4 v[40:43], v1, s[40:43], s64 offen offset:2048 sc1
    s_add_u32 s64, s68, 4096
    buffer_load_dwordx4 v[44:47], v1, s[40:43], s64 offen offset:3072 sc1
    s_add_u32 s64, s68, 8192
    buffer_load_dwordx4 v[48:51], v1, s[40:43], s64 offen offset:0 sc1
    s_add_u32 s64, s68, 73728
    buffer_load_dwordx4 v[52:55], v1, s[40:43], s64 offen offset:0 sc1
    s_add_u32 s64, s68, 73728
    buffer_load_dwordx4 v[56:59], v1, s[40:43], s64 offen offset:1024 sc1
    s_add_u32 s64, s68, 73728
    buffer_load_dwordx4 v[60:63], v1, s[40:43], s64 offen offset:2048 sc1
    s_waitcnt vmcnt(11)
    v_mfma_f32_16x16x32_bf16 v[64:67], v[112:115], v[16:19], 0
    v_mfma_f32_16x16x32_bf16 v[68:71], v[116:119], v[16:19], 0
    v_mfma_f32_16x16x32_bf16 v[72:75], v[120:123], v[16:19], 0
    v_mfma_f32_16x16x32_bf16 v[76:79], v[124:127], v[16:19], 0
    s_add_u32 s64, s68, 73728
    buffer_load_dwordx4 v[16:19], v1, s[40:43], s64 offen offset:3072 sc1
    s_waitcnt vmcnt(11)
    v_mfma_f32_16x16x32_bf16 v[64:67], v[128:131], v[20:23], v[64:67]
    v_mfma_f32_16x16x32_bf16 v[68:71], v[132:135], v[20:23], v[68:71]
    v_mfma_f32_16x16x32_bf16 v[72:75], v[136:139], v[20:23], v[72:75]
    v_mfma_f32_16x16x32_bf16 v[76:79], v[140:143], v[20:23], v[76:79]
    s_add_u32 s64, s68, 77824
    buffer_load_dwordx4 v[20:23], v1, s[40:43], s64 offen offset:0 sc1
    s_waitcnt vmcnt(11)
    v_mfma_f32_16x16x32_bf16 v[64:67], v[144:147], v[24:27], v[64:67]
    v_mfma_f32_16x16x32_bf16 v[68:71], v[148:151], v[24:27], v[68:71]
    v_mfma_f32_16x16x32_bf16 v[72:75], v[152:155], v[24:27], v[72:75]
    v_mfma_f32_16x16x32_bf16 v[76:79], v[156:159], v[24:27], v[76:79]
    s_add_u32 s64, s68, 77824
    buffer_load_dwordx4 v[24:27], v1, s[40:43], s64 offen offset:1024 sc1
    s_waitcnt vmcnt(11)
    v_mfma_f32_16x16x32_bf16 v[64:67], v[160:163], v[28:31], v[64:67]
    v_mfma_f32_16x16x32_bf16 v[68:71], v[164:167], v[28:31], v[68:71]
    v_mfma_f32_16x16x32_bf16 v[72:75], v[168:171], v[28:31], v[72:75]
    v_mfma_f32_16x16x32_bf16 v[76:79], v[172:175], v[28:31], v[76:79]
    s_add_u32 s64, s68, 77824
    buffer_load_dwordx4 v[28:31], v1, s[40:43], s64 offen offset:2048 sc1
    s_waitcnt vmcnt(11)
    v_mfma_f32_16x16x32_bf16 v[64:67], v[176:179], v[32:35], v[64:67]
    v_mfma_f32_16x16x32_bf16 v[68:71], v[180:183], v[32:35], v[68:71]
    v_mfma_f32_16x16x32_bf16 v[72:75], v[184:187], v[32:35], v[72:75]
    v_mfma_f32_16x16x32_bf16 v[76:79], v[188:191], v[32:35], v[76:79]
    s_add_u32 s64, s68, 77824
    buffer_load_dwordx4 v[32:35], v1, s[40:43], s64 offen offset:3072 sc1
    s_waitcnt vmcnt(11)
    v_mfma_f32_16x16x32_bf16 v[64:67], v[192:195], v[36:39], v[64:67]
    v_mfma_f32_16x16x32_bf16 v[68:71], v[196:199], v[36:39], v[68:71]
    v_mfma_f32_16x16x32_bf16 v[72:75], v[200:203], v[36:39], v[72:75]
    v_mfma_f32_16x16x32_bf16 v[76:79], v[204:207], v[36:39], v[76:79]
    s_add_u32 s64, s68, 81920
    buffer_load_dwordx4 v[36:39], v1, s[40:43], s64 offen offset:0 sc1
    s_waitcnt vmcnt(11)
    v_mfma_f32_16x16x32_bf16 v[64:67], v[208:211], v[40:43], v[64:67]
    v_mfma_f32_16x16x32_bf16 v[68:71], v[212:215], v[40:43], v[68:71]
    v_mfma_f32_16x16x32_bf16 v[72:75], v[216:219], v[40:43], v[72:75]
    v_mfma_f32_16x16x32_bf16 v[76:79], v[220:223], v[40:43], v[76:79]
    s_add_u32 s64, s68, 147456
    buffer_load_dwordx4 v[40:43], v1, s[40:43], s64 offen offset:0 sc1
    s_waitcnt vmcnt(11)
    v_mfma_f32_16x16x32_bf16 v[64:67], v[224:227], v[44:47], v[64:67]
    v_mfma_f32_16x16x32_bf16 v[68:71], v[228:231], v[44:47], v[68:71]
    v_mfma_f32_16x16x32_bf16 v[72:75], v[232:235], v[44:47], v[72:75]
    v_mfma_f32_16x16x32_bf16 v[76:79], v[236:239], v[44:47], v[76:79]
    s_add_u32 s64, s68, 147456
    buffer_load_dwordx4 v[44:47], v1, s[40:43], s64 offen offset:1024 sc1
    s_waitcnt vmcnt(11)
    v_mfma_f32_16x16x32_bf16 v[64:67], v[240:243], v[48:51], v[64:67]
    v_mfma_f32_16x16x32_bf16 v[68:71], v[244:247], v[48:51], v[68:71]
    v_mfma_f32_16x16x32_bf16 v[72:75], v[248:251], v[48:51], v[72:75]
    v_mfma_f32_16x16x32_bf16 v[76:79], v[252:255], v[48:51], v[76:79]
    s_add_u32 s64, s68, 147456
    buffer_load_dwordx4 v[48:51], v1, s[40:43], s64 offen offset:2048 sc1
    s_waitcnt vmcnt(11)
    v_mfma_f32_16x16x32_bf16 v[80:83], v[112:115], v[52:55], 0
    v_mfma_f32_16x16x32_bf16 v[84:87], v[116:119], v[52:55], 0
    v_mfma_f32_16x16x32_bf16 v[88:91], v[120:123], v[52:55], 0
    v_mfma_f32_16x16x32_bf16 v[92:95], v[124:127], v[52:55], 0
    ds_write_b128 v2, v[64:67] offset:0
    ds_write_b128 v2, v[68:71] offset:1024
    s_add_u32 s64, s68, 147456
    buffer_load_dwordx4 v[52:55], v1, s[40:43], s64 offen offset:3072 sc1
    s_waitcnt vmcnt(11)
    v_mfma_f32_16x16x32_bf16 v[80:83], v[128:131], v[56:59], v[80:83]
    v_mfma_f32_16x16x32_bf16 v[84:87], v[132:135], v[56:59], v[84:87]
    v_mfma_f32_16x16x32_bf16 v[88:91], v[136:139], v[56:59], v[88:91]
    v_mfma_f32_16x16x32_bf16 v[92:95], v[140:143], v[56:59], v[92:95]
    ds_write_b128 v2, v[72:75] offset:2048
    ds_write_b128 v2, v[76:79] offset:3072
    s_add_u32 s64, s68, 151552
    buffer_load_dwordx4 v[56:59], v1, s[40:43], s64 offen offset:0 sc1
    s_waitcnt vmcnt(11)
    v_mfma_f32_16x16x32_bf16 v[80:83], v[144:147], v[60:63], v[80:83]
    v_mfma_f32_16x16x32_bf16 v[84:87], v[148:151], v[60:63], v[84:87]
    v_mfma_f32_16x16x32_bf16 v[88:91], v[152:155], v[60:63], v[88:91]
    v_mfma_f32_16x16x32_bf16 v[92:95], v[156:159], v[60:63], v[92:95]
    v_mov_b32 v98, 0
    v_mov_b32 v99, 1
    s_mov_b64 exec, 1
    ds_add_u32 v98, v99 offset:48
    s_mov_b64 exec, -1
    s_add_u32 s64, s68, 151552
    buffer_load_dwordx4 v[60:63], v1, s[40:43], s64 offen offset:1024 sc1
    s_waitcnt vmcnt(11)
    v_mfma_f32_16x16x32_bf16 v[80:83], v[160:163], v[16:19], v[80:83]
    v_mfma_f32_16x16x32_bf16 v[84:87], v[164:167], v[16:19], v[84:87]
    v_mfma_f32_16x16x32_bf16 v[88:91], v[168:171], v[16:19], v[88:91]
    v_mfma_f32_16x16x32_bf16 v[92:95], v[172:175], v[16:19], v[92:95]
    s_add_u32 s64, s68, 151552
    buffer_load_dwordx4 v[16:19], v1, s[40:43], s64 offen offset:2048 sc1
    s_waitcnt vmcnt(11)
    v_mfma_f32_16x16x32_bf16 v[80:83], v[176:179], v[20:23], v[80:83]
    v_mfma_f32_16x16x32_bf16 v[84:87], v[180:183], v[20:23], v[84:87]
    v_mfma_f32_16x16x32_bf16 v[88:91], v[184:187], v[20:23], v[88:91]
    v_mfma_f32_16x16x32_bf16 v[92:95], v[188:191], v[20:23], v[92:95]
    s_add_u32 s64, s68, 151552
    buffer_load_dwordx4 v[20:23], v1, s[40:43], s64 offen offset:3072 sc1
    s_waitcnt vmcnt(11)
    v_mfma_f32_16x16x32_bf16 v[80:83], v[192:195], v[24:27], v[80:83]
    v_mfma_f32_16x16x32_bf16 v[84:87], v[196:199], v[24:27], v[84:87]
    v_mfma_f32_16x16x32_bf16 v[88:91], v[200:203], v[24:27], v[88:91]
    v_mfma_f32_16x16x32_bf16 v[92:95], v[204:207], v[24:27], v[92:95]
    s_add_u32 s64, s68, 155648
    buffer_load_dwordx4 v[24:27], v1, s[40:43], s64 offen offset:0 sc1
    s_waitcnt vmcnt(11)
    v_mfma_f32_16x16x32_bf16 v[80:83], v[208:211], v[28:31], v[80:83]
    v_mfma_f32_16x16x32_bf16 v[84:87], v[212:215], v[28:31], v[84:87]
    v_mfma_f32_16x16x32_bf16 v[88:91], v[216:219], v[28:31], v[88:91]
    v_mfma_f32_16x16x32_bf16 v[92:95], v[220:223], v[28:31], v[92:95]
    s_add_u32 s64, s68, 221184
    buffer_load_dwordx4 v[28:31], v1, s[40:43], s64 offen offset:0 sc1
    s_waitcnt vmcnt(11)
    v_mfma_f32_16x16x32_bf16 v[80:83], v[224:227], v[32:35], v[80:83]
    v_mfma_f32_16x16x32_bf16 v[84:87], v[228:231], v[32:35], v[84:87]
    v_mfma_f32_16x16x32_bf16 v[88:91], v[232:235], v[32:35], v[88:91]
    v_mfma_f32_16x16x32_bf16 v[92:95], v[236:239], v[32:35], v[92:95]
    s_add_u32 s64, s68, 221184
    buffer_load_dwordx4 v[32:35], v1, s[40:43], s64 offen offset:1024 sc1
    s_waitcnt vmcnt(11)
    v_mfma_f32_16x16x32_bf16 v[80:83], v[240:243], v[36:39], v[80:83]
    v_mfma_f32_16x16x32_bf16 v[84:87], v[244:247], v[36:39], v[84:87]
    v_mfma_f32_16x16x32_bf16 v[88:91], v[248:251], v[36:39], v[88:91]
    v_mfma_f32_16x16x32_bf16 v[92:95], v[252:255], v[36:39], v[92:95]
    s_add_u32 s64, s68, 221184
    buffer_load_dwordx4 v[36:39], v1, s[40:43], s64 offen offset:2048 sc1
    s_waitcnt vmcnt(11)
    v_mfma_f32_16x16x32_bf16 v[64:67], v[112:115], v[40:43], 0
    v_mfma_f32_16x16x32_bf16 v[68:71], v[116:119], v[40:43], 0
    v_mfma_f32_16x16x32_bf16 v[72:75], v[120:123], v[40:43], 0
    v_mfma_f32_16x16x32_bf16 v[76:79], v[124:127], v[40:43], 0
    ds_write_b128 v2, v[80:83] offset:16384
    ds_write_b128 v2, v[84:87] offset:17408
    s_add_u32 s64, s68, 221184
    buffer_load_dwordx4 v[40:43], v1, s[40:43], s64 offen offset:3072 sc1
    s_waitcnt vmcnt(11)
    v_mfma_f32_16x16x32_bf16 v[64:67], v[128:131], v[44:47], v[64:67]
    v_mfma_f32_16x16x32_bf16 v[68:71], v[132:135], v[44:47], v[68:71]
    v_mfma_f32_16x16x32_bf16 v[72:75], v[136:139], v[44:47], v[72:75]
    v_mfma_f32_16x16x32_bf16 v[76:79], v[140:143], v[44:47], v[76:79]
    ds_write_b128 v2, v[88:91] offset:18432
    ds_write_b128 v2, v[92:95] offset:19456
    s_add_u32 s64, s68, 225280
    buffer_load_dwordx4 v[44:47], v1, s[40:43], s64 offen offset:0 sc1
    s_waitcnt vmcnt(11)
    v_mfma_f32_16x16x32_bf16 v[64:67], v[144:147], v[48:51], v[64:67]
    v_mfma_f32_16x16x32_bf16 v[68:71], v[148:151], v[48:51], v[68:71]
    v_mfma_f32_16x16x32_bf16 v[72:75], v[152:155], v[48:51], v[72:75]
    v_mfma_f32_16x16x32_bf16 v[76:79], v[156:159], v[48:51], v[76:79]
    v_mov_b32 v98, 0
    v_mov_b32 v99, 1
    s_mov_b64 exec, 1
    ds_add_u32 v98, v99 offset:52
    s_mov_b64 exec, -1
    s_add_u32 s64, s68, 225280
    buffer_load_dwordx4 v[48:51], v1, s[40:43], s64 offen offset:1024 sc1
    s_waitcnt vmcnt(11)
    v_mfma_f32_16x16x32_bf16 v[64:67], v[160:163], v[52:55], v[64:67]
    v_mfma_f32_16x16x32_bf16 v[68:71], v[164:167], v[52:55], v[68:71]
    v_mfma_f32_16x16x32_bf16 v[72:75], v[168:171], v[52:55], v[72:75]
    v_mfma_f32_16x16x32_bf16 v[76:79], v[172:175], v[52:55], v[76:79]
    s_add_u32 s64, s68, 225280
    buffer_load_dwordx4 v[52:55], v1, s[40:43], s64 offen offset:2048 sc1
    s_waitcnt vmcnt(11)
    v_mfma_f32_16x16x32_bf16 v[64:67], v[176:179], v[56:59], v[64:67]
    v_mfma_f32_16x16x32_bf16 v[68:71], v[180:183], v[56:59], v[68:71]
    v_mfma_f32_16x16x32_bf16 v[72:75], v[184:187], v[56:59], v[72:75]
    v_mfma_f32_16x16x32_bf16 v[76:79], v[188:191], v[56:59], v[76:79]
    s_add_u32 s64, s68, 225280
    buffer_load_dwordx4 v[56:59], v1, s[40:43], s64 offen offset:3072 sc1
    s_waitcnt vmcnt(11)
    v_mfma_f32_16x16x32_bf16 v[64:67], v[192:195], v[60:63], v[64:67]
    v_mfma_f32_16x16x32_bf16 v[68:71], v[196:199], v[60:63], v[68:71]
    v_mfma_f32_16x16x32_bf16 v[72:75], v[200:203], v[60:63], v[72:75]
    v_mfma_f32_16x16x32_bf16 v[76:79], v[204:207], v[60:63], v[76:79]
    s_add_u32 s64, s68, 229376
    buffer_load_dwordx4 v[60:63], v1, s[40:43], s64 offen offset:0 sc1
    s_waitcnt vmcnt(11)
    v_mfma_f32_16x16x32_bf16 v[64:67], v[208:211], v[16:19], v[64:67]
    v_mfma_f32_16x16x32_bf16 v[68:71], v[212:215], v[16:19], v[68:71]
    v_mfma_f32_16x16x32_bf16 v[72:75], v[216:219], v[16:19], v[72:75]
    v_mfma_f32_16x16x32_bf16 v[76:79], v[220:223], v[16:19], v[76:79]
    s_add_u32 s64, s19, 0
    buffer_load_dwordx4 v[16:19], v1, s[40:43], s64 offen offset:0 sc1
    s_waitcnt vmcnt(11)
    v_mfma_f32_16x16x32_bf16 v[64:67], v[224:227], v[20:23], v[64:67]
    v_mfma_f32_16x16x32_bf16 v[68:71], v[228:231], v[20:23], v[68:71]
    v_mfma_f32_16x16x32_bf16 v[72:75], v[232:235], v[20:23], v[72:75]
    v_mfma_f32_16x16x32_bf16 v[76:79], v[236:239], v[20:23], v[76:79]
    s_add_u32 s64, s19, 0
    buffer_load_dwordx4 v[20:23], v1, s[40:43], s64 offen offset:1024 sc1
    s_waitcnt vmcnt(11)
    v_mfma_f32_16x16x32_bf16 v[64:67], v[240:243], v[24:27], v[64:67]
    v_mfma_f32_16x16x32_bf16 v[68:71], v[244:247], v[24:27], v[68:71]
    v_mfma_f32_16x16x32_bf16 v[72:75], v[248:251], v[24:27], v[72:75]
    v_mfma_f32_16x16x32_bf16 v[76:79], v[252:255], v[24:27], v[76:79]
    s_add_u32 s64, s19, 0
    buffer_load_dwordx4 v[24:27], v1, s[40:43], s64 offen offset:2048 sc1
    s_waitcnt vmcnt(11)
    v_mfma_f32_16x16x32_bf16 v[80:83], v[112:115], v[28:31], 0
    v_mfma_f32_16x16x32_bf16 v[84:87], v[116:119], v[28:31], 0
    v_mfma_f32_16x16x32_bf16 v[88:91], v[120:123], v[28:31], 0
    v_mfma_f32_16x16x32_bf16 v[92:95], v[124:127], v[28:31], 0
    ds_write_b128 v2, v[64:67] offset:32768
    ds_write_b128 v2, v[68:71] offset:33792
    s_add_u32 s64, s19, 0
    buffer_load_dwordx4 v[28:31], v1, s[40:43], s64 offen offset:3072 sc1
    s_waitcnt vmcnt(11)
    v_mfma_f32_16x16x32_bf16 v[80:83], v[128:131], v[32:35], v[80:83]
    v_mfma_f32_16x16x32_bf16 v[84:87], v[132:135], v[32:35], v[84:87]
    v_mfma_f32_16x16x32_bf16 v[88:91], v[136:139], v[32:35], v[88:91]
    v_mfma_f32_16x16x32_bf16 v[92:95], v[140:143], v[32:35], v[92:95]
    ds_write_b128 v2, v[72:75] offset:34816
    ds_write_b128 v2, v[76:79] offset:35840
    s_add_u32 s64, s19, 4096
    buffer_load_dwordx4 v[32:35], v1, s[40:43], s64 offen offset:0 sc1
    s_waitcnt vmcnt(11)
    v_mfma_f32_16x16x32_bf16 v[80:83], v[144:147], v[36:39], v[80:83]
    v_mfma_f32_16x16x32_bf16 v[84:87], v[148:151], v[36:39], v[84:87]
    v_mfma_f32_16x16x32_bf16 v[88:91], v[152:155], v[36:39], v[88:91]
    v_mfma_f32_16x16x32_bf16 v[92:95], v[156:159], v[36:39], v[92:95]
    v_mov_b32 v98, 0
    v_mov_b32 v99, 1
    s_mov_b64 exec, 1
    ds_add_u32 v98, v99 offset:56
    s_mov_b64 exec, -1
    s_add_u32 s64, s19, 4096
    buffer_load_dwordx4 v[36:39], v1, s[40:43], s64 offen offset:1024 sc1
    s_waitcnt vmcnt(11)
    v_mfma_f32_16x16x32_bf16 v[80:83], v[160:163], v[40:43], v[80:83]
    v_mfma_f32_16x16x32_bf16 v[84:87], v[164:167], v[40:43], v[84:87]
    v_mfma_f32_16x16x32_bf16 v[88:91], v[168:171], v[40:43], v[88:91]
    v_mfma_f32_16x16x32_bf16 v[92:95], v[172:175], v[40:43], v[92:95]
    s_add_u32 s64, s19, 4096
    buffer_load_dwordx4 v[40:43], v1, s[40:43], s64 offen offset:2048 sc1
    s_waitcnt vmcnt(11)
    v_mfma_f32_16x16x32_bf16 v[80:83], v[176:179], v[44:47], v[80:83]
    v_mfma_f32_16x16x32_bf16 v[84:87], v[180:183], v[44:47], v[84:87]
    v_mfma_f32_16x16x32_bf16 v[88:91], v[184:187], v[44:47], v[88:91]
    v_mfma_f32_16x16x32_bf16 v[92:95], v[188:191], v[44:47], v[92:95]
    s_add_u32 s64, s19, 4096
    buffer_load_dwordx4 v[44:47], v1, s[40:43], s64 offen offset:3072 sc1
    s_waitcnt vmcnt(11)
    v_mfma_f32_16x16x32_bf16 v[80:83], v[192:195], v[48:51], v[80:83]
    v_mfma_f32_16x16x32_bf16 v[84:87], v[196:199], v[48:51], v[84:87]
    v_mfma_f32_16x16x32_bf16 v[88:91], v[200:203], v[48:51], v[88:91]
    v_mfma_f32_16x16x32_bf16 v[92:95], v[204:207], v[48:51], v[92:95]
    s_add_u32 s64, s19, 8192
    buffer_load_dwordx4 v[48:51], v1, s[40:43], s64 offen offset:0 sc1
    s_waitcnt vmcnt(11)
    v_mfma_f32_16x16x32_bf16 v[80:83], v[208:211], v[52:55], v[80:83]
    v_mfma_f32_16x16x32_bf16 v[84:87], v[212:215], v[52:55], v[84:87]
    v_mfma_f32_16x16x32_bf16 v[88:91], v[216:219], v[52:55], v[88:91]
    v_mfma_f32_16x16x32_bf16 v[92:95], v[220:223], v[52:55], v[92:95]
    s_add_u32 s64, s19, 73728
    buffer_load_dwordx4 v[52:55], v1, s[40:43], s64 offen offset:0 sc1
    s_waitcnt vmcnt(11)
    v_mfma_f32_16x16x32_bf16 v[80:83], v[224:227], v[56:59], v[80:83]
    v_mfma_f32_16x16x32_bf16 v[84:87], v[228:231], v[56:59], v[84:87]
    v_mfma_f32_16x16x32_bf16 v[88:91], v[232:235], v[56:59], v[88:91]
    v_mfma_f32_16x16x32_bf16 v[92:95], v[236:239], v[56:59], v[92:95]
    s_add_u32 s64, s19, 73728
    buffer_load_dwordx4 v[56:59], v1, s[40:43], s64 offen offset:1024 sc1
    s_waitcnt vmcnt(11)
    v_mfma_f32_16x16x32_bf16 v[80:83], v[240:243], v[60:63], v[80:83]
    v_mfma_f32_16x16x32_bf16 v[84:87], v[244:247], v[60:63], v[84:87]
    v_mfma_f32_16x16x32_bf16 v[88:91], v[248:251], v[60:63], v[88:91]
    v_mfma_f32_16x16x32_bf16 v[92:95], v[252:255], v[60:63], v[92:95]
    s_add_u32 s64, s19, 73728
    buffer_load_dwordx4 v[60:63], v1, s[40:43], s64 offen offset:2048 sc1
    s_waitcnt vmcnt(11)
    v_mfma_f32_16x16x32_bf16 v[64:67], v[112:115], v[16:19], 0
    v_mfma_f32_16x16x32_bf16 v[68:71], v[116:119], v[16:19], 0
    v_mfma_f32_16x16x32_bf16 v[72:75], v[120:123], v[16:19], 0
    v_mfma_f32_16x16x32_bf16 v[76:79], v[124:127], v[16:19], 0
    ds_write_b128 v2, v[80:83] offset:49152
    ds_write_b128 v2, v[84:87] offset:50176
    s_add_u32 s64, s19, 73728
    buffer_load_dwordx4 v[16:19], v1, s[40:43], s64 offen offset:3072 sc1
    s_waitcnt vmcnt(11)
    v_mfma_f32_16x16x32_bf16 v[64:67], v[128:131], v[20:23], v[64:67]
    v_mfma_f32_16x16x32_bf16 v[68:71], v[132:135], v[20:23], v[68:71]
    v_mfma_f32_16x16x32_bf16 v[72:75], v[136:139], v[20:23], v[72:75]
    v_mfma_f32_16x16x32_bf16 v[76:79], v[140:143], v[20:23], v[76:79]
    ds_write_b128 v2, v[88:91] offset:51200
    ds_write_b128 v2, v[92:95] offset:52224
    s_add_u32 s64, s19, 77824
    buffer_load_dwordx4 v[20:23], v1, s[40:43], s64 offen offset:0 sc1
    s_waitcnt vmcnt(11)
    v_mfma_f32_16x16x32_bf16 v[64:67], v[144:147], v[24:27], v[64:67]
    v_mfma_f32_16x16x32_bf16 v[68:71], v[148:151], v[24:27], v[68:71]
    v_mfma_f32_16x16x32_bf16 v[72:75], v[152:155], v[24:27], v[72:75]
    v_mfma_f32_16x16x32_bf16 v[76:79], v[156:159], v[24:27], v[76:79]
    v_mov_b32 v98, 0
    v_mov_b32 v99, 1
    s_mov_b64 exec, 1
    ds_add_u32 v98, v99 offset:60
    s_mov_b64 exec, -1
    s_add_u32 s64, s19, 77824
    buffer_load_dwordx4 v[24:27], v1, s[40:43], s64 offen offset:1024 sc1
    s_waitcnt vmcnt(11)
    v_mfma_f32_16x16x32_bf16 v[64:67], v[160:163], v[28:31], v[64:67]
    v_mfma_f32_16x16x32_bf16 v[68:71], v[164:167], v[28:31], v[68:71]
    v_mfma_f32_16x16x32_bf16 v[72:75], v[168:171], v[28:31], v[72:75]
    v_mfma_f32_16x16x32_bf16 v[76:79], v[172:175], v[28:31], v[76:79]
    s_add_u32 s64, s19, 77824
    buffer_load_dwordx4 v[28:31], v1, s[40:43], s64 offen offset:2048 sc1
    s_waitcnt vmcnt(11)
    v_mfma_f32_16x16x32_bf16 v[64:67], v[176:179], v[32:35], v[64:67]
    v_mfma_f32_16x16x32_bf16 v[68:71], v[180:183], v[32:35], v[68:71]
    v_mfma_f32_16x16x32_bf16 v[72:75], v[184:187], v[32:35], v[72:75]
    v_mfma_f32_16x16x32_bf16 v[76:79], v[188:191], v[32:35], v[76:79]
    s_add_u32 s64, s19, 77824
    buffer_load_dwordx4 v[32:35], v1, s[40:43], s64 offen offset:3072 sc1
    s_waitcnt vmcnt(11)
    v_mfma_f32_16x16x32_bf16 v[64:67], v[192:195], v[36:39], v[64:67]
    v_mfma_f32_16x16x32_bf16 v[68:71], v[196:199], v[36:39], v[68:71]
    v_mfma_f32_16x16x32_bf16 v[72:75], v[200:203], v[36:39], v[72:75]
    v_mfma_f32_16x16x32_bf16 v[76:79], v[204:207], v[36:39], v[76:79]
    s_add_u32 s64, s19, 81920
    buffer_load_dwordx4 v[36:39], v1, s[40:43], s64 offen offset:0 sc1
    s_waitcnt vmcnt(11)
    v_mfma_f32_16x16x32_bf16 v[64:67], v[208:211], v[40:43], v[64:67]
    v_mfma_f32_16x16x32_bf16 v[68:71], v[212:215], v[40:43], v[68:71]
    v_mfma_f32_16x16x32_bf16 v[72:75], v[216:219], v[40:43], v[72:75]
    v_mfma_f32_16x16x32_bf16 v[76:79], v[220:223], v[40:43], v[76:79]
    s_add_u32 s64, s19, 147456
    buffer_load_dwordx4 v[40:43], v1, s[40:43], s64 offen offset:0 sc1
    s_waitcnt vmcnt(11)
    v_mfma_f32_16x16x32_bf16 v[64:67], v[224:227], v[44:47], v[64:67]
    v_mfma_f32_16x16x32_bf16 v[68:71], v[228:231], v[44:47], v[68:71]
    v_mfma_f32_16x16x32_bf16 v[72:75], v[232:235], v[44:47], v[72:75]
    v_mfma_f32_16x16x32_bf16 v[76:79], v[236:239], v[44:47], v[76:79]
    s_add_u32 s64, s19, 147456
    buffer_load_dwordx4 v[44:47], v1, s[40:43], s64 offen offset:1024 sc1
    s_waitcnt vmcnt(11)
    v_mfma_f32_16x16x32_bf16 v[64:67], v[240:243], v[48:51], v[64:67]
    v_mfma_f32_16x16x32_bf16 v[68:71], v[244:247], v[48:51], v[68:71]
    v_mfma_f32_16x16x32_bf16 v[72:75], v[248:251], v[48:51], v[72:75]
    v_mfma_f32_16x16x32_bf16 v[76:79], v[252:255], v[48:51], v[76:79]
    s_add_u32 s64, s19, 147456
    buffer_load_dwordx4 v[48:51], v1, s[40:43], s64 offen offset:2048 sc1
    s_waitcnt vmcnt(11)
    v_mfma_f32_16x16x32_bf16 v[80:83], v[112:115], v[52:55], 0
    v_mfma_f32_16x16x32_bf16 v[84:87], v[116:119], v[52:55], 0
    v_mfma_f32_16x16x32_bf16 v[88:91], v[120:123], v[52:55], 0
    v_mfma_f32_16x16x32_bf16 v[92:95], v[124:127], v[52:55], 0
    s_add_u32 s64, s19, 147456
    buffer_load_dwordx4 v[52:55], v1, s[40:43], s64 offen offset:3072 sc1
    s_waitcnt vmcnt(11)
    v_mfma_f32_16x16x32_bf16 v[80:83], v[128:131], v[56:59], v[80:83]
    v_mfma_f32_16x16x32_bf16 v[84:87], v[132:135], v[56:59], v[84:87]
    v_mfma_f32_16x16x32_bf16 v[88:91], v[136:139], v[56:59], v[88:91]
    v_mfma_f32_16x16x32_bf16 v[92:95], v[140:143], v[56:59], v[92:95]
    s_add_u32 s64, s19, 151552
    buffer_load_dwordx4 v[56:59], v1, s[40:43], s64 offen offset:0 sc1
    s_waitcnt vmcnt(11)
    v_mfma_f32_16x16x32_bf16 v[80:83], v[144:147], v[60:63], v[80:83]
    v_mfma_f32_16x16x32_bf16 v[84:87], v[148:151], v[60:63], v[84:87]
    v_mfma_f32_16x16x32_bf16 v[88:91], v[152:155], v[60:63], v[88:91]
    v_mfma_f32_16x16x32_bf16 v[92:95], v[156:159], v[60:63], v[92:95]
    s_add_u32 s64, s19, 151552
    buffer_load_dwordx4 v[60:63], v1, s[40:43], s64 offen offset:1024 sc1
    s_waitcnt vmcnt(11)
    v_mfma_f32_16x16x32_bf16 v[80:83], v[160:163], v[16:19], v[80:83]
    v_mfma_f32_16x16x32_bf16 v[84:87], v[164:167], v[16:19], v[84:87]
    v_mfma_f32_16x16x32_bf16 v[88:91], v[168:171], v[16:19], v[88:91]
    v_mfma_f32_16x16x32_bf16 v[92:95], v[172:175], v[16:19], v[92:95]
    s_add_u32 s64, s19, 151552
    buffer_load_dwordx4 v[16:19], v1, s[40:43], s64 offen offset:2048 sc1
    s_waitcnt vmcnt(11)
    v_mfma_f32_16x16x32_bf16 v[80:83], v[176:179], v[20:23], v[80:83]
    v_mfma_f32_16x16x32_bf16 v[84:87], v[180:183], v[20:23], v[84:87]
    v_mfma_f32_16x16x32_bf16 v[88:91], v[184:187], v[20:23], v[88:91]
    v_mfma_f32_16x16x32_bf16 v[92:95], v[188:191], v[20:23], v[92:95]
    s_add_u32 s64, s19, 151552
    buffer_load_dwordx4 v[20:23], v1, s[40:43], s64 offen offset:3072 sc1
    s_waitcnt vmcnt(11)
    v_mfma_f32_16x16x32_bf16 v[80:83], v[192:195], v[24:27], v[80:83]
    v_mfma_f32_16x16x32_bf16 v[84:87], v[196:199], v[24:27], v[84:87]
    v_mfma_f32_16x16x32_bf16 v[88:91], v[200:203], v[24:27], v[88:91]
    v_mfma_f32_16x16x32_bf16 v[92:95], v[204:207], v[24:27], v[92:95]
    s_add_u32 s64, s19, 155648
    buffer_load_dwordx4 v[24:27], v1, s[40:43], s64 offen offset:0 sc1
    s_waitcnt vmcnt(11)
    v_mfma_f32_16x16x32_bf16 v[80:83], v[208:211], v[28:31], v[80:83]
    v_mfma_f32_16x16x32_bf16 v[84:87], v[212:215], v[28:31], v[84:87]
    v_mfma_f32_16x16x32_bf16 v[88:91], v[216:219], v[28:31], v[88:91]
    v_mfma_f32_16x16x32_bf16 v[92:95], v[220:223], v[28:31], v[92:95]
    s_add_u32 s64, s19, 221184
    buffer_load_dwordx4 v[28:31], v1, s[40:43], s64 offen offset:0 sc1
    s_waitcnt vmcnt(11)
    v_mfma_f32_16x16x32_bf16 v[80:83], v[224:227], v[32:35], v[80:83]
    v_mfma_f32_16x16x32_bf16 v[84:87], v[228:231], v[32:35], v[84:87]
    v_mfma_f32_16x16x32_bf16 v[88:91], v[232:235], v[32:35], v[88:91]
    v_mfma_f32_16x16x32_bf16 v[92:95], v[236:239], v[32:35], v[92:95]
    s_add_u32 s64, s19, 221184
    buffer_load_dwordx4 v[32:35], v1, s[40:43], s64 offen offset:1024 sc1
    s_waitcnt vmcnt(11)
    v_mfma_f32_16x16x32_bf16 v[80:83], v[240:243], v[36:39], v[80:83]
    v_mfma_f32_16x16x32_bf16 v[84:87], v[244:247], v[36:39], v[84:87]
    v_mfma_f32_16x16x32_bf16 v[88:91], v[248:251], v[36:39], v[88:91]
    v_mfma_f32_16x16x32_bf16 v[92:95], v[252:255], v[36:39], v[92:95]
    s_mov_b32 s70, 40000
    v_mov_b32 v98, 0
CW_10:
    ds_read_b32 v99, v98 offset:12
    s_waitcnt lgkmcnt(0)
    v_readfirstlane_b32 s71, v99
    s_nop 0
    s_cmp_ge_u32 s71, 4
    s_cbranch_scc1 CWD_11
    s_sub_u32 s70, s70, 1
    s_cbranch_scc1 CWD_11
    s_sleep 1
    s_branch CW_10
CWD_11:
    ds_write_b128 v2, v[64:67] offset:0
    ds_write_b128 v2, v[68:71] offset:1024
    ds_write_b128 v2, v[72:75] offset:2048
    ds_write_b128 v2, v[76:79] offset:3072
    v_mov_b32 v98, 0
    v_mov_b32 v99, 1
    s_mov_b64 exec, 1
    ds_add_u32 v98, v99 offset:48
    s_mov_b64 exec, -1
    s_add_u32 s64, s19, 221184
    buffer_load_dwordx4 v[36:39], v1, s[40:43], s64 offen offset:2048 sc1
    s_waitcnt vmcnt(11)
    v_mfma_f32_16x16x32_bf16 v[64:67], v[112:115], v[40:43], 0
    v_mfma_f32_16x16x32_bf16 v[68:71], v[116:119], v[40:43], 0
    v_mfma_f32_16x16x32_bf16 v[72:75], v[120:123], v[40:43], 0
    v_mfma_f32_16x16x32_bf16 v[76:79], v[124:127], v[40:43], 0
    ds_write_b128 v2, v[80:83] offset:16384
    ds_write_b128 v2, v[84:87] offset:17408
    s_add_u32 s64, s19, 221184
    buffer_load_dwordx4 v[40:43], v1, s[40:43], s64 offen offset:3072 sc1
    s_waitcnt vmcnt(11)
    v_mfma_f32_16x16x32_bf16 v[64:67], v[128:131], v[44:47], v[64:67]
    v_mfma_f32_16x16x32_bf16 v[68:71], v[132:135], v[44:47], v[68:71]
    v_mfma_f32_16x16x32_bf16 v[72:75], v[136:139], v[44:47], v[72:75]
    v_mfma_f32_16x16x32_bf16 v[76:79], v[140:143], v[44:47], v[76:79]
    ds_write_b128 v2, v[88:91] offset:18432
    ds_write_b128 v2, v[92:95] offset:19456
    s_add_u32 s64, s19, 225280
    buffer_load_dwordx4 v[44:47], v1, s[40:43], s64 offen offset:0 sc1
    s_waitcnt vmcnt(11)
    v_mfma_f32_16x16x32_bf16 v[64:67], v[144:147], v[48:51], v[64:67]
    v_mfma_f32_16x16x32_bf16 v[68:71], v[148:151], v[48:51], v[68:71]
    v_mfma_f32_16x16x32_bf16 v[72:75], v[152:155], v[48:51], v[72:75]
    v_mfma_f32_16x16x32_bf16 v[76:79], v[156:159], v[48:51], v[76:79]
    v_mov_b32 v98, 0
    v_mov_b32 v99, 1
    s_mov_b64 exec, 1
    ds_add_u32 v98, v99 offset:52
    s_mov_b64 exec, -1
    s_add_u32 s64, s19, 225280
    buffer_load_dwordx4 v[48:51], v1, s[40:43], s64 offen offset:1024 sc1
    s_waitcnt vmcnt(11)
    v_mfma_f32_16x16x32_bf16 v[64:67], v[160:163], v[52:55], v[64:67]
    v_mfma_f32_16x16x32_bf16 v[68:71], v[164:167], v[52:55], v[68:71]
    v_mfma_f32_16x16x32_bf16 v[72:75], v[168:171], v[52:55], v[72:75]
    v_mfma_f32_16x16x32_bf16 v[76:79], v[172:175], v[52:55], v[76:79]
    s_add_u32 s64, s19, 225280
    buffer_load_dwordx4 v[52:55], v1, s[40:43], s64 offen offset:2048 sc1
    s_waitcnt vmcnt(11)
    v_mfma_f32_16x16x32_bf16 v[64:67], v[176:179], v[56:59], v[64:67]
    v_mfma_f32_16x16x32_bf16 v[68:71], v[180:183], v[56:59], v[68:71]
    v_mfma_f32_16x16x32_bf16 v[72:75], v[184:187], v[56:59], v[72:75]
    v_mfma_f32_16x16x32_bf16 v[76:79], v[188:191], v[56:59], v[76:79]
    s_add_u32 s64, s19, 225280
    buffer_load_dwordx4 v[56:59], v1, s[40:43], s64 offen offset:3072 sc1
    s_waitcnt vmcnt(11)
    v_mfma_f32_16x16x32_bf16 v[64:67], v[192:195], v[60:63], v[64:67]
    v_mfma_f32_16x16x32_bf16 v[68:71], v[196:199], v[60:63], v[68:71]
    v_mfma_f32_16x16x32_bf16 v[72:75], v[200:203], v[60:63], v[72:75]
    v_mfma_f32_16x16x32_bf16 v[76:79], v[204:207], v[60:63], v[76:79]
    s_add_u32 s64, s19, 229376
    buffer_load_dwordx4 v[60:63], v1, s[40:43], s64 offen offset:0 sc1
    buffer_load_dword v7, v6, s[40:43], s10 offen sc1
    s_waitcnt vmcnt(12)
    v_mfma_f32_16x16x32_bf16 v[64:67], v[208:211], v[16:19], v[64:67]
    v_mfma_f32_16x16x32_bf16 v[68:71], v[212:215], v[16:19], v[68:71]
    v_mfma_f32_16x16x32_bf16 v[72:75], v[216:219], v[16:19], v[72:75]
    v_mfma_f32_16x16x32_bf16 v[76:79], v[220:223], v[16:19], v[76:79]
    s_waitcnt vmcnt(11)
    v_mfma_f32_16x16x32_bf16 v[64:67], v[224:227], v[20:23], v[64:67]
    v_mfma_f32_16x16x32_bf16 v[68:71], v[228:231], v[20:23], v[68:71]
    v_mfma_f32_16x16x32_bf16 v[72:75], v[232:235], v[20:23], v[72:75]
    v_mfma_f32_16x16x32_bf16 v[76:79], v[236:239], v[20:23], v[76:79]
    s_waitcnt vmcnt(10)
    v_mfma_f32_16x16x32_bf16 v[64:67], v[240:243], v[24:27], v[64:67]
    v_mfma_f32_16x16x32_bf16 v[68:71], v[244:247], v[24:27], v[68:71]
    v_mfma_f32_16x16x32_bf16 v[72:75], v[248:251], v[24:27], v[72:75]
    v_mfma_f32_16x16x32_bf16 v[76:79], v[252:255], v[24:27], v[76:79]
    s_waitcnt vmcnt(9)
    v_mfma_f32_16x16x32_bf16 v[80:83], v[112:115], v[28:31], 0
    v_mfma_f32_16x16x32_bf16 v[84:87], v[116:119], v[28:31], 0
    v_mfma_f32_16x16x32_bf16 v[88:91], v[120:123], v[28:31], 0
    v_mfma_f32_16x16x32_bf16 v[92:95], v[124:127], v[28:31], 0
    ds_write_b128 v2, v[64:67] offset:32768
    ds_write_b128 v2, v[68:71] offset:33792
    s_waitcnt vmcnt(8)
    v_mfma_f32_16x16x32_bf16 v[80:83], v[128:131], v[32:35], v[80:83]
    v_mfma_f32_16x16x32_bf16 v[84:87], v[132:135], v[32:35], v[84:87]
    v_mfma_f32_16x16x32_bf16 v[88:91], v[136:139], v[32:35], v[88:91]
    v_mfma_f32_16x16x32_bf16 v[92:95], v[140:143], v[32:35], v[92:95]
    ds_write_b128 v2, v[72:75] offset:34816
    ds_write_b128 v2, v[76:79] offset:35840
    s_waitcnt vmcnt(7)
    v_mfma_f32_16x16x32_bf16 v[80:83], v[144:147], v[36:39], v[80:83]
    v_mfma_f32_16x16x32_bf16 v[84:87], v[148:151], v[36:39], v[84:87]
    v_mfma_f32_16x16x32_bf16 v[88:91], v[152:155], v[36:39], v[88:91]
    v_mfma_f32_16x16x32_bf16 v[92:95], v[156:159], v[36:39], v[92:95]
    v_mov_b32 v98, 0
    v_mov_b32 v99, 1
    s_mov_b64 exec, 1
    ds_add_u32 v98, v99 offset:56
    s_mov_b64 exec, -1
    s_waitcnt vmcnt(6)
    v_mfma_f32_16x16x32_bf16 v[80:83], v[160:163], v[40:43], v[80:83]
    v_mfma_f32_16x16x32_bf16 v[84:87], v[164:167], v[40:43], v[84:87]
    v_mfma_f32_16x16x32_bf16 v[88:91], v[168:171], v[40:43], v[88:91]
    v_mfma_f32_16x16x32_bf16 v[92:95], v[172:175], v[40:43], v[92:95]
    s_waitcnt vmcnt(5)
    v_mfma_f32_16x16x32_bf16 v[80:83], v[176:179], v[44:47], v[80:83]
    v_mfma_f32_16x16x32_bf16 v[84:87], v[180:183], v[44:47], v[84:87]
    v_mfma_f32_16x16x32_bf16 v[88:91], v[184:187], v[44:47], v[88:91]
    v_mfma_f32_16x16x32_bf16 v[92:95], v[188:191], v[44:47], v[92:95]
    s_waitcnt vmcnt(4)
    v_mfma_f32_16x16x32_bf16 v[80:83], v[192:195], v[48:51], v[80:83]
    v_mfma_f32_16x16x32_bf16 v[84:87], v[196:199], v[48:51], v[84:87]
    v_mfma_f32_16x16x32_bf16 v[88:91], v[200:203], v[48:51], v[88:91]
    v_mfma_f32_16x16x32_bf16 v[92:95], v[204:207], v[48:51], v[92:95]
    s_waitcnt vmcnt(3)
    v_mfma_f32_16x16x32_bf16 v[80:83], v[208:211], v[52:55], v[80:83]
    v_mfma_f32_16x16x32_bf16 v[84:87], v[212:215], v[52:55], v[84:87]
    v_mfma_f32_16x16x32_bf16 v[88:91], v[216:219], v[52:55], v[88:91]
    v_mfma_f32_16x16x32_bf16 v[92:95], v[220:223], v[52:55], v[92:95]
    s_waitcnt vmcnt(2)
    v_mfma_f32_16x16x32_bf16 v[80:83], v[224:227], v[56:59], v[80:83]
    v_mfma_f32_16x16x32_bf16 v[84:87], v[228:231], v[56:59], v[84:87]
    v_mfma_f32_16x16x32_bf16 v[88:91], v[232:235], v[56:59], v[88:91]
    v_mfma_f32_16x16x32_bf16 v[92:95], v[236:239], v[56:59], v[92:95]
    s_waitcnt vmcnt(1)
    v_mfma_f32_16x16x32_bf16 v[80:83], v[240:243], v[60:63], v[80:83]
    v_mfma_f32_16x16x32_bf16 v[84:87], v[244:247], v[60:63], v[84:87]
    v_mfma_f32_16x16x32_bf16 v[88:91], v[248:251], v[60:63], v[88:91]
    v_mfma_f32_16x16x32_bf16 v[92:95], v[252:255], v[60:63], v[92:95]
    s_nop 4
    ds_write_b128 v2, v[80:83] offset:49152
    ds_write_b128 v2, v[84:87] offset:50176
    ds_write_b128 v2, v[88:91] offset:51200
    ds_write_b128 v2, v[92:95] offset:52224
    v_mov_b32 v98, 0
    v_mov_b32 v99, 1
    s_mov_b64 exec, 1
    ds_add_u32 v98, v99 offset:60
    s_mov_b64 exec, -1
    s_mov_b32 s67, -1
    s_mov_b32 s70, 40000
    s_waitcnt vmcnt(0)
    s_branch FPC_14
FP_12:
    buffer_load_dword v7, v6, s[40:43], s10 offen sc1
    s_waitcnt vmcnt(0)
FPC_14:
    v_cmp_eq_u32 vcc, s62, v7
    s_nop 0
    s_and_b32 s71, vcc_lo, s67
    s_cmp_eq_u32 s71, s67
    s_cbranch_scc1 FPD_13
    s_sub_u32 s70, s70, 1
    s_cbranch_scc1 FPD_13
    s_sleep 1
    s_branch FP_12
FPD_13:
    v_and_b32 v6, 15, v0
    v_lshlrev_b32 v6, 4, v6
    v_bfe_u32 v7, v0, 4, 1
    v_lshl_or_b32 v6, v7, 9, v6
    v_lshrrev_b32 v7, 5, v0
    v_lshl_or_b32 v6, v7, 10, v6
    buffer_load_dwordx4 v[104:107], v6, s[40:43], s11 offen sc1
    buffer_load_dwordx4 v[108:111], v6, s[40:43], s11 offen offset:256 sc1
    buffer_load_dwordx4 v[112:115], v6, s[40:43], s11 offen offset:2048 sc1
    buffer_load_dwordx4 v[116:119], v6, s[40:43], s11 offen offset:2304 sc1
    s_branch L_FINL
L_LATT:
    s_waitcnt vmcnt(12)
    s_waitcnt lgkmcnt(0)
    s_barrier
    s_call_b64 s[6:7], L_ISSUE
    s_waitcnt vmcnt(12)
    s_waitcnt lgkmcnt(0)
    s_barrier
    s_call_b64 s[6:7], L_ISSUE
    buffer_load_dwordx4 v[56:59], v54, s[40:43], 0 offen
    s_add_u32 s64, s56, 4
    s_and_b32 s64, s64, 15
    s_lshl_b32 s64, s64, 11
    s_add_u32 s64, s64, s17
    buffer_load_dwordx2 v[80:81], v64, s[40:43], s64 offen
    s_add_u32 s64, s56, 8
    s_and_b32 s64, s64, 15
    s_lshl_b32 s64, s64, 11
    s_add_u32 s64, s64, s17
    buffer_load_dwordx2 v[82:83], v64, s[40:43], s64 offen
    s_add_u32 s64, s56, 12
    s_and_b32 s64, s64, 15
    s_lshl_b32 s64, s64, 11
    s_add_u32 s64, s64, s17
    buffer_load_dwordx2 v[84:85], v64, s[40:43], s64 offen
    s_waitcnt vmcnt(15)
    s_waitcnt lgkmcnt(0)
    s_barrier
    s_call_b64 s[6:7], L_ISSUE
    s_waitcnt vmcnt(15)
    s_waitcnt lgkmcnt(0)
    s_barrier
    s_call_b64 s[6:7], L_ISSUE
    s_add_u32 m0, s21, 0xc000
    s_add_u32 s64, s23, 0
    s_lshl_b32 s64, s64, 15
    buffer_load_dwordx4 v8, s[32:35], s64 offen offset:0 lds
    buffer_load_dwordx4 v9, s[32:35], s64 offen offset:1024 lds
    buffer_load_dwordx4 v10, s[32:35], s64 offen offset:2048 lds
    buffer_load_dwordx4 v11, s[32:35], s64 offen offset:3072 lds
    s_waitcnt vmcnt(15)
    s_waitcnt lgkmcnt(0)
    s_barrier
    s_mov_b32 s70, 40000
GC_15:
    v_max_u32 v66, v59, v81
    v_min_u32 v67, v59, v81
    v_max3_u32 v66, v66, v83, v85
    v_min3_u32 v67, v67, v83, v85
    v_cmp_eq_u32 vcc, s62, v66
    s_nop 0
    s_mov_b64 s[64:65], vcc
    v_cmp_eq_u32 vcc, s62, v67
    s_nop 0
    s_and_b64 s[64:65], s[64:65], vcc
    s_cmp_eq_u64 s[64:65], -1
    s_cbranch_scc1 GCD_16
    s_sub_u32 s70, s70, 1
    s_cbranch_scc1 GCD_16
    s_sleep 1
    buffer_load_dwordx4 v[56:59], v54, s[40:43], 0 offen sc1
    s_add_u32 s64, s56, 4
    s_and_b32 s64, s64, 15
    s_lshl_b32 s64, s64, 11
    s_add_u32 s64, s64, s17
    buffer_load_dwordx2 v[80:81], v64, s[40:43], s64 offen sc1
    s_add_u32 s64, s56, 8
    s_and_b32 s64, s64, 15
    s_lshl_b32 s64, s64, 11
    s_add_u32 s64, s64, s17
    buffer_load_dwordx2 v[82:83], v64, s[40:43], s64 offen sc1
    s_add_u32 s64, s56, 12
    s_and_b32 s64, s64, 15
    s_lshl_b32 s64, s64, 11
    s_add_u32 s64, s64, s17
    buffer_load_dwordx2 v[84:85], v64, s[40:43], s64 offen sc1
    s_waitcnt vmcnt(0)
    s_branch GC_15
GCD_16:
    v_add_f32 v48, v48, v80
    v_add_f32 v48, v48, v82
    v_add_f32 v48, v48, v84
    s_lshl_b32 s64, s60, 8
    v_lshl_add_u32 v66, v0, 2, s64
    ds_write_b32 v66, v48 offset:3072
    ds_write_b32 v66, v56 offset:1024
    ds_write_b32 v66, v57 offset:2048
    v_cmp_eq_u32 vcc, s15, v58
    s_nop 0
    s_cmp_eq_u64 vcc, -1
    s_cselect_b32 s63, 1, 0
    v_mov_b32 v60, s62
    v_mov_b32 v61, s63
    v_mov_b32 v55, 0
    s_mov_b64 exec, 1
    ds_write_b32 v55, v60 offset:0
    ds_min_u32 v55, v61 offset:4
    s_mov_b64 exec, -1
    s_waitcnt vmcnt(0)
    ds_read_b64_tr_b16 v[112:113], v12 offset:49152
    ds_read_b64_tr_b16 v[114:115], v12 offset:51200
    ds_read_b64_tr_b16 v[116:117], v13 offset:49152
    ds_read_b64_tr_b16 v[118:119], v13 offset:51200
    ds_read_b64_tr_b16 v[120:121], v14 offset:49152
    ds_read_b64_tr_b16 v[122:123], v14 offset:51200
    ds_read_b64_tr_b16 v[124:125], v15 offset:49152
    ds_read_b64_tr_b16 v[126:127], v15 offset:51200
    s_waitcnt lgkmcnt(0)
    s_add_u32 m0, s21, 0x0
    s_add_u32 s64, s23, 1
    s_lshl_b32 s64, s64, 15
    buffer_load_dwordx4 v8, s[32:35], s64 offen offset:0 lds
    buffer_load_dwordx4 v9, s[32:35], s64 offen offset:1024 lds
    buffer_load_dwordx4 v10, s[32:35], s64 offen offset:2048 lds
    buffer_load_dwordx4 v11, s[32:35], s64 offen offset:3072 lds
    s_add_u32 m0, s21, 0x4000
    s_add_u32 s64, s23, 2
    s_lshl_b32 s64, s64, 15
    buffer_load_dwordx4 v8, s[32:35], s64 offen offset:0 lds
    buffer_load_dwordx4 v9, s[32:35], s64 offen offset:1024 lds
    buffer_load_dwordx4 v10, s[32:35], s64 offen offset:2048 lds
    buffer_load_dwordx4 v11, s[32:35], s64 offen offset:3072 lds
    s_waitcnt lgkmcnt(0)
    s_barrier
    s_add_u32 m0, s21, 0x8000
    s_add_u32 s64, s23, 3
    s_lshl_b32 s64, s64, 15
    buffer_load_dwordx4 v8, s[32:35], s64 offen offset:0 lds
    buffer_load_dwordx4 v9, s[32:35], s64 offen offset:1024 lds
    buffer_load_dwordx4 v10, s[32:35], s64 offen offset:2048 lds
    buffer_load_dwordx4 v11, s[32:35], s64 offen offset:3072 lds
    s_add_u32 m0, s21, 0xc000
    s_add_u32 s64, s23, 4
    s_lshl_b32 s64, s64, 15
    buffer_load_dwordx4 v8, s[32:35], s64 offen offset:0 lds
    buffer_load_dwordx4 v9, s[32:35], s64 offen offset:1024 lds
    buffer_load_dwordx4 v10, s[32:35], s64 offen offset:2048 lds
    buffer_load_dwordx4 v11, s[32:35], s64 offen offset:3072 lds
    s_lshl_b32 s64, s60, 8
    v_lshl_add_u32 v5, v0, 2, s64
    v_lshlrev_b32 v6, 6, v0
    v_bfe_u32 v2, v0, 2, 1
    v_lshl_or_b32 v6, v2, 5, v6
    v_bfe_u32 v2, v0, 3, 1
    v_lshl_or_b32 v6, v2, 4, v6
    s_lshl_b32 s64, s60, 12
    v_add_u32 v6, s64, v6
    ds_read_b32 v7, v5 offset:2048
    s_waitcnt lgkmcnt(0)
    v_mul_f32 v7, 0x3fb8aa3b, v7
    s_barrier
    v_add_u32 v1, 4096, v6
    v_xor_b32 v2, 16, v1
    v_xor_b32 v3, 32, v1
    v_xor_b32 v4, 48, v1
    v_mov_b32 v64, v7
    ds_read_b128 v[16:19], v1 offset:0
    ds_read_b128 v[20:23], v2 offset:0
    ds_read_b128 v[24:27], v3 offset:0
    ds_read_b128 v[28:31], v4 offset:0
    ds_read_b128 v[80:83], v1 offset:16384
    ds_read_b128 v[84:87], v2 offset:16384
    ds_read_b128 v[88:91], v3 offset:16384
    ds_read_b128 v[92:95], v4 offset:16384
    s_waitcnt lgkmcnt(7)
    v_max3_f32 v66, v16, v17, v18
    v_min3_f32 v68, v16, v17, v18
    s_waitcnt lgkmcnt(6)
    v_max3_f32 v66, v66, v19, v20
    v_min3_f32 v68, v68, v19, v20
    v_max3_f32 v66, v66, v21, v22
    v_min3_f32 v68, v68, v21, v22
    s_waitcnt lgkmcnt(5)
    v_max3_f32 v66, v66, v23, v24
    v_min3_f32 v68, v68, v23, v24
    s_waitcnt vmcnt(12)
    ds_read_b64_tr_b16 v[128:129], v12 offset:0
    ds_read_b64_tr_b16 v[130:131], v12 offset:2048
    ds_read_b64_tr_b16 v[132:133], v13 offset:0
    ds_read_b64_tr_b16 v[134:135], v13 offset:2048
    ds_read_b64_tr_b16 v[136:137], v14 offset:0
    ds_read_b64_tr_b16 v[138:139], v14 offset:2048
    ds_read_b64_tr_b16 v[140:141], v15 offset:0
    ds_read_b64_tr_b16 v[142:143], v15 offset:2048
    v_max3_f32 v66, v66, v25, v26
    v_min3_f32 v68, v68, v25, v26
    s_waitcnt lgkmcnt(12)
    v_max3_f32 v66, v66, v27, v28
    v_min3_f32 v68, v68, v27, v28
    v_max3_f32 v66, v66, v29, v30
    v_min3_f32 v68, v68, v29, v30
    v_max_f32 v66, v66, v31
    v_min_f32 v68, v68, v31
    s_waitcnt vmcnt(8)
    ds_read_b64_tr_b16 v[144:145], v12 offset:16384
    ds_read_b64_tr_b16 v[146:147], v12 offset:18432
    ds_read_b64_tr_b16 v[148:149], v13 offset:16384
    ds_read_b64_tr_b16 v[150:151], v13 offset:18432
    ds_read_b64_tr_b16 v[152:153], v14 offset:16384
    ds_read_b64_tr_b16 v[154:155], v14 offset:18432
    ds_read_b64_tr_b16 v[156:157], v15 offset:16384
    ds_read_b64_tr_b16 v[158:159], v15 offset:18432
    v_mul_f32 v66, v66, v64
    v_mul_f32 v68, v68, v64
    v_pk_fma_f32 v[32:33], v[16:17], v[64:65], v[66:67] op_sel_hi:[1,0,0] neg_lo:[0,0,1] neg_hi:[0,0,1]
    v_pk_fma_f32 v[16:17], v[16:17], v[64:65], v[68:69] op_sel_hi:[1,0,0] neg_lo:[1,0,0] neg_hi:[1,0,0]
    v_pk_fma_f32 v[34:35], v[18:19], v[64:65], v[66:67] op_sel_hi:[1,0,0] neg_lo:[0,0,1] neg_hi:[0,0,1]
    v_pk_fma_f32 v[18:19], v[18:19], v[64:65], v[68:69] op_sel_hi:[1,0,0] neg_lo:[1,0,0] neg_hi:[1,0,0]
    v_pk_fma_f32 v[36:37], v[20:21], v[64:65], v[66:67] op_sel_hi:[1,0,0] neg_lo:[0,0,1] neg_hi:[0,0,1]
    v_pk_fma_f32 v[20:21], v[20:21], v[64:65], v[68:69] op_sel_hi:[1,0,0] neg_lo:[1,0,0] neg_hi:[1,0,0]
    s_waitcnt vmcnt(4)
    ds_read_b64_tr_b16 v[160:161], v12 offset:32768
    ds_read_b64_tr_b16 v[162:163], v12 offset:34816
    ds_read_b64_tr_b16 v[164:165], v13 offset:32768
    ds_read_b64_tr_b16 v[166:167], v13 offset:34816
    ds_read_b64_tr_b16 v[168:169], v14 offset:32768
    ds_read_b64_tr_b16 v[170:171], v14 offset:34816
    ds_read_b64_tr_b16 v[172:173], v15 offset:32768
    ds_read_b64_tr_b16 v[174:175], v15 offset:34816
    v_pk_fma_f32 v[38:39], v[22:23], v[64:65], v[66:67] op_sel_hi:[1,0,0] neg_lo:[0,0,1] neg_hi:[0,0,1]
    v_pk_fma_f32 v[22:23], v[22:23], v[64:65], v[68:69] op_sel_hi:[1,0,0] neg_lo:[1,0,0] neg_hi:[1,0,0]
    v_pk_fma_f32 v[40:41], v[24:25], v[64:65], v[66:67] op_sel_hi:[1,0,0] neg_lo:[0,0,1] neg_hi:[0,0,1]
    v_pk_fma_f32 v[24:25], v[24:25], v[64:65], v[68:69] op_sel_hi:[1,0,0] neg_lo:[1,0,0] neg_hi:[1,0,0]
    v_pk_fma_f32 v[42:43], v[26:27], v[64:65], v[66:67] op_sel_hi:[1,0,0] neg_lo:[0,0,1] neg_hi:[0,0,1]
    v_pk_fma_f32 v[26:27], v[26:27], v[64:65], v[68:69] op_sel_hi:[1,0,0] neg_lo:[1,0,0] neg_hi:[1,0,0]
    v_pk_fma_f32 v[44:45], v[28:29], v[64:65], v[66:67] op_sel_hi:[1,0,0] neg_lo:[0,0,1] neg_hi:[0,0,1]
    v_pk_fma_f32 v[28:29], v[28:29], v[64:65], v[68:69] op_sel_hi:[1,0,0] neg_lo:[1,0,0] neg_hi:[1,0,0]
    s_waitcnt vmcnt(0)
    ds_read_b64_tr_b16 v[176:177], v12 offset:49152
    ds_read_b64_tr_b16 v[178:179], v12 offset:51200
    ds_read_b64_tr_b16 v[180:181], v13 offset:49152
    ds_read_b64_tr_b16 v[182:183], v13 offset:51200
    ds_read_b64_tr_b16 v[184:185], v14 offset:49152
    ds_read_b64_tr_b16 v[186:187], v14 offset:51200
    ds_read_b64_tr_b16 v[188:189], v15 offset:49152
    ds_read_b64_tr_b16 v[190:191], v15 offset:51200
    v_pk_fma_f32 v[46:47], v[30:31], v[64:65], v[66:67] op_sel_hi:[1,0,0] neg_lo:[0,0,1] neg_hi:[0,0,1]
    v_pk_fma_f32 v[30:31], v[30:31], v[64:65], v[68:69] op_sel_hi:[1,0,0] neg_lo:[1,0,0] neg_hi:[1,0,0]
    v_exp_f32 v32, v32
    v_exp_f32 v16, v16
    v_exp_f32 v33, v33
    v_exp_f32 v17, v17
    v_exp_f32 v34, v34
    v_exp_f32 v18, v18
    s_waitcnt lgkmcnt(14)
    s_add_u32 m0, s21, 0
    s_add_u32 s64, s22, 0
    s_lshl_b32 s64, s64, 15
    buffer_load_dwordx4 v8, s[36:39], s64 offen offset:0 lds
    v_exp_f32 v35, v35
    v_exp_f32 v19, v19
    v_exp_f32 v36, v36
    v_exp_f32 v20, v20
    v_exp_f32 v37, v37
    v_exp_f32 v21, v21
    v_exp_f32 v38, v38
    v_exp_f32 v22, v22
    s_add_u32 m0, s21, 0
    s_add_u32 s64, s22, 0
    s_lshl_b32 s64, s64, 15
    buffer_load_dwordx4 v9, s[36:39], s64 offen offset:1024 lds
    v_exp_f32 v39, v39
    v_exp_f32 v23, v23
    v_exp_f32 v40, v40
    v_exp_f32 v24, v24
    v_exp_f32 v41, v41
    v_exp_f32 v25, v25
    v_exp_f32 v42, v42
    v_exp_f32 v26, v26
    s_add_u32 m0, s21, 0
    s_add_u32 s64, s22, 0
    s_lshl_b32 s64, s64, 15
    buffer_load_dwordx4 v10, s[36:39], s64 offen offset:2048 lds
    v_exp_f32 v43, v43
    v_exp_f32 v27, v27
    v_exp_f32 v44, v44
    v_exp_f32 v28, v28
    v_exp_f32 v45, v45
    v_exp_f32 v29, v29
    v_exp_f32 v46, v46
    v_exp_f32 v30, v30
    s_add_u32 m0, s21, 0
    s_add_u32 s64, s22, 0
    s_lshl_b32 s64, s64, 15
    buffer_load_dwordx4 v11, s[36:39], s64 offen offset:3072 lds
    v_exp_f32 v47, v47
    v_exp_f32 v31, v31
    v_pk_add_f32 v[66:67], v[32:33], v[34:35]
    v_pk_add_f32 v[70:71], v[36:37], v[38:39]
    v_pk_add_f32 v[68:69], v[16:17], v[18:19]
    v_pk_add_f32 v[72:73], v[20:21], v[22:23]
    v_pk_add_f32 v[66:67], v[66:67], v[40:41]
    v_pk_add_f32 v[70:71], v[70:71], v[42:43]
    s_add_u32 m0, s21, 16384
    s_add_u32 s64, s22, 1
    s_lshl_b32 s64, s64, 15
    buffer_load_dwordx4 v8, s[36:39], s64 offen offset:0 lds
    v_pk_add_f32 v[68:69], v[68:69], v[24:25]
    v_pk_add_f32 v[72:73], v[72:73], v[26:27]
    v_pk_add_f32 v[66:67], v[66:67], v[44:45]
    v_pk_add_f32 v[70:71], v[70:71], v[46:47]
    v_pk_add_f32 v[68:69], v[68:69], v[28:29]
    v_pk_add_f32 v[72:73], v[72:73], v[30:31]
    v_pk_add_f32 v[66:67], v[66:67], v[70:71]
    v_pk_add_f32 v[68:69], v[68:69], v[72:73]
    s_add_u32 m0, s21, 16384
    s_add_u32 s64, s22, 1
    s_lshl_b32 s64, s64, 15
    buffer_load_dwordx4 v9, s[36:39], s64 offen offset:1024 lds
    v_add_f32 v66, v66, v67
    v_add_f32 v68, v68, v69
    v_rcp_f32 v66, v66
    v_rcp_f32 v68, v68
    v_pk_mul_f32 v[32:33], v[32:33], v[66:67] op_sel_hi:[1,0]
    v_pk_mul_f32 v[34:35], v[34:35], v[66:67] op_sel_hi:[1,0]
    v_pk_mul_f32 v[16:17], v[16:17], v[68:69] op_sel_hi:[1,0]
    v_pk_mul_f32 v[18:19], v[18:19], v[68:69] op_sel_hi:[1,0]
    s_add_u32 m0, s21, 16384
    s_add_u32 s64, s22, 1
    s_lshl_b32 s64, s64, 15
    buffer_load_dwordx4 v10, s[36:39], s64 offen offset:2048 lds
    v_cvt_pk_bf16_f32 v48, v32, v33
    v_cvt_pk_bf16_f32 v49, v34, v35
    v_cvt_pk_bf16_f32 v50, v16, v17
    v_cvt_pk_bf16_f32 v51, v18, v19
    ds_write_b128 v1, v[48:51] offset:0
    v_pk_mul_f32 v[36:37], v[36:37], v[66:67] op_sel_hi:[1,0]
    v_pk_mul_f32 v[38:39], v[38:39], v[66:67] op_sel_hi:[1,0]
    v_pk_mul_f32 v[20:21], v[20:21], v[68:69] op_sel_hi:[1,0]
    s_add_u32 m0, s21, 16384
    s_add_u32 s64, s22, 1
    s_lshl_b32 s64, s64, 15
    buffer_load_dwordx4 v11, s[36:39], s64 offen offset:3072 lds
    v_pk_mul_f32 v[22:23], v[22:23], v[68:69] op_sel_hi:[1,0]
    v_cvt_pk_bf16_f32 v52, v36, v37
    v_cvt_pk_bf16_f32 v53, v38, v39
    v_cvt_pk_bf16_f32 v54, v20, v21
    v_cvt_pk_bf16_f32 v55, v22, v23
    ds_write_b128 v2, v[52:55] offset:0
    v_pk_mul_f32 v[40:41], v[40:41], v[66:67] op_sel_hi:[1,0]
    v_pk_mul_f32 v[42:43], v[42:43], v[66:67] op_sel_hi:[1,0]
    s_waitcnt lgkmcnt(10)
    s_add_u32 m0, s21, 32768
    s_add_u32 s64, s22, 2
    s_lshl_b32 s64, s64, 15
    buffer_load_dwordx4 v8, s[36:39], s64 offen offset:0 lds
    v_pk_mul_f32 v[24:25], v[24:25], v[68:69] op_sel_hi:[1,0]
    v_pk_mul_f32 v[26:27], v[26:27], v[68:69] op_sel_hi:[1,0]
    v_cvt_pk_bf16_f32 v56, v40, v41
    v_cvt_pk_bf16_f32 v57, v42, v43
    v_cvt_pk_bf16_f32 v58, v24, v25
    v_cvt_pk_bf16_f32 v59, v26, v27
    ds_write_b128 v3, v[56:59] offset:0
    v_pk_mul_f32 v[44:45], v[44:45], v[66:67] op_sel_hi:[1,0]
    s_add_u32 m0, s21, 32768
    s_add_u32 s64, s22, 2
    s_lshl_b32 s64, s64, 15
    buffer_load_dwordx4 v9, s[36:39], s64 offen offset:1024 lds
    v_pk_mul_f32 v[46:47], v[46:47], v[66:67] op_sel_hi:[1,0]
    v_pk_mul_f32 v[28:29], v[28:29], v[68:69] op_sel_hi:[1,0]
    v_pk_mul_f32 v[30:31], v[30:31], v[68:69] op_sel_hi:[1,0]
    v_cvt_pk_bf16_f32 v60, v44, v45
    v_cvt_pk_bf16_f32 v61, v46, v47
    v_cvt_pk_bf16_f32 v62, v28, v29
    v_cvt_pk_bf16_f32 v63, v30, v31
    ds_write_b128 v4, v[60:63] offset:0
    s_add_u32 m0, s21, 32768
    s_add_u32 s64, s22, 2
    s_lshl_b32 s64, s64, 15
    buffer_load_dwordx4 v10, s[36:39], s64 offen offset:2048 lds
    v_max3_f32 v66, v80, v81, v82
    v_min3_f32 v68, v80, v81, v82
    v_max3_f32 v66, v66, v83, v84
    v_min3_f32 v68, v68, v83, v84
    v_max3_f32 v66, v66, v85, v86
    v_min3_f32 v68, v68, v85, v86
    v_max3_f32 v66, v66, v87, v88
    v_min3_f32 v68, v68, v87, v88
    s_add_u32 m0, s21, 32768
    s_add_u32 s64, s22, 2
    s_lshl_b32 s64, s64, 15
    buffer_load_dwordx4 v11, s[36:39], s64 offen offset:3072 lds
    v_max3_f32 v66, v66, v89, v90
    v_min3_f32 v68, v68, v89, v90
    v_max3_f32 v66, v66, v91, v92
    v_min3_f32 v68, v68, v91, v92
    v_max3_f32 v66, v66, v93, v94
    v_min3_f32 v68, v68, v93, v94
    v_max_f32 v66, v66, v95
    v_min_f32 v68, v68, v95
    s_waitcnt lgkmcnt(4)
    s_add_u32 m0, s21, 49152
    s_add_u32 s64, s22, 3
    s_lshl_b32 s64, s64, 15
    buffer_load_dwordx4 v8, s[36:39], s64 offen offset:0 lds
    v_mul_f32 v66, v66, v64
    v_mul_f32 v68, v68, v64
    v_pk_fma_f32 v[32:33], v[80:81], v[64:65], v[66:67] op_sel_hi:[1,0,0] neg_lo:[0,0,1] neg_hi:[0,0,1]
    v_pk_fma_f32 v[80:81], v[80:81], v[64:65], v[68:69] op_sel_hi:[1,0,0] neg_lo:[1,0,0] neg_hi:[1,0,0]
    v_pk_fma_f32 v[34:35], v[82:83], v[64:65], v[66:67] op_sel_hi:[1,0,0] neg_lo:[0,0,1] neg_hi:[0,0,1]
    v_pk_fma_f32 v[82:83], v[82:83], v[64:65], v[68:69] op_sel_hi:[1,0,0] neg_lo:[1,0,0] neg_hi:[1,0,0]
    v_pk_fma_f32 v[36:37], v[84:85], v[64:65], v[66:67] op_sel_hi:[1,0,0] neg_lo:[0,0,1] neg_hi:[0,0,1]
    v_pk_fma_f32 v[84:85], v[84:85], v[64:65], v[68:69] op_sel_hi:[1,0,0] neg_lo:[1,0,0] neg_hi:[1,0,0]
    s_add_u32 m0, s21, 49152
    s_add_u32 s64, s22, 3
    s_lshl_b32 s64, s64, 15
    buffer_load_dwordx4 v9, s[36:39], s64 offen offset:1024 lds
    v_pk_fma_f32 v[38:39], v[86:87], v[64:65], v[66:67] op_sel_hi:[1,0,0] neg_lo:[0,0,1] neg_hi:[0,0,1]
    v_pk_fma_f32 v[86:87], v[86:87], v[64:65], v[68:69] op_sel_hi:[1,0,0] neg_lo:[1,0,0] neg_hi:[1,0,0]
    v_pk_fma_f32 v[40:41], v[88:89], v[64:65], v[66:67] op_sel_hi:[1,0,0] neg_lo:[0,0,1] neg_hi:[0,0,1]
    v_pk_fma_f32 v[88:89], v[88:89], v[64:65], v[68:69] op_sel_hi:[1,0,0] neg_lo:[1,0,0] neg_hi:[1,0,0]
    v_pk_fma_f32 v[42:43], v[90:91], v[64:65], v[66:67] op_sel_hi:[1,0,0] neg_lo:[0,0,1] neg_hi:[0,0,1]
    v_pk_fma_f32 v[90:91], v[90:91], v[64:65], v[68:69] op_sel_hi:[1,0,0] neg_lo:[1,0,0] neg_hi:[1,0,0]
    v_pk_fma_f32 v[44:45], v[92:93], v[64:65], v[66:67] op_sel_hi:[1,0,0] neg_lo:[0,0,1] neg_hi:[0,0,1]
    v_pk_fma_f32 v[92:93], v[92:93], v[64:65], v[68:69] op_sel_hi:[1,0,0] neg_lo:[1,0,0] neg_hi:[1,0,0]
    s_add_u32 m0, s21, 49152
    s_add_u32 s64, s22, 3
    s_lshl_b32 s64, s64, 15
    buffer_load_dwordx4 v10, s[36:39], s64 offen offset:2048 lds
    v_pk_fma_f32 v[46:47], v[94:95], v[64:65], v[66:67] op_sel_hi:[1,0,0] neg_lo:[0,0,1] neg_hi:[0,0,1]
    v_pk_fma_f32 v[94:95], v[94:95], v[64:65], v[68:69] op_sel_hi:[1,0,0] neg_lo:[1,0,0] neg_hi:[1,0,0]
    v_exp_f32 v32, v32
    v_exp_f32 v80, v80
    v_exp_f32 v33, v33
    v_exp_f32 v81, v81
    v_exp_f32 v34, v34
    v_exp_f32 v82, v82
    s_add_u32 m0, s21, 49152
    s_add_u32 s64, s22, 3
    s_lshl_b32 s64, s64, 15
    buffer_load_dwordx4 v11, s[36:39], s64 offen offset:3072 lds
    v_exp_f32 v35, v35
    v_exp_f32 v83, v83
    v_exp_f32 v36, v36
    v_exp_f32 v84, v84
    v_exp_f32 v37, v37
    v_exp_f32 v85, v85
    v_exp_f32 v38, v38
    v_exp_f32 v86, v86
    v_exp_f32 v39, v39
    v_exp_f32 v87, v87
    v_exp_f32 v40, v40
    v_exp_f32 v88, v88
    v_exp_f32 v41, v41
    v_exp_f32 v89, v89
    v_exp_f32 v42, v42
    v_exp_f32 v90, v90
    v_exp_f32 v43, v43
    v_exp_f32 v91, v91
    v_exp_f32 v44, v44
    v_exp_f32 v92, v92
    v_exp_f32 v45, v45
    v_exp_f32 v93, v93
    v_exp_f32 v46, v46
    v_exp_f32 v94, v94
    v_exp_f32 v47, v47
    v_exp_f32 v95, v95
    v_pk_add_f32 v[66:67], v[32:33], v[34:35]
    v_pk_add_f32 v[70:71], v[36:37], v[38:39]
    v_pk_add_f32 v[68:69], v[80:81], v[82:83]
    v_pk_add_f32 v[72:73], v[84:85], v[86:87]
    v_pk_add_f32 v[66:67], v[66:67], v[40:41]
    v_pk_add_f32 v[70:71], v[70:71], v[42:43]
    v_pk_add_f32 v[68:69], v[68:69], v[88:89]
    v_pk_add_f32 v[72:73], v[72:73], v[90:91]
    v_pk_add_f32 v[66:67], v[66:67], v[44:45]
    v_pk_add_f32 v[70:71], v[70:71], v[46:47]
    v_pk_add_f32 v[68:69], v[68:69], v[92:93]
    v_pk_add_f32 v[72:73], v[72:73], v[94:95]
    v_pk_add_f32 v[66:67], v[66:67], v[70:71]
    v_pk_add_f32 v[68:69], v[68:69], v[72:73]
    v_add_f32 v66, v66, v67
    v_add_f32 v68, v68, v69
    v_rcp_f32 v66, v66
    v_rcp_f32 v68, v68
    v_pk_mul_f32 v[32:33], v[32:33], v[66:67] op_sel_hi:[1,0]
    v_pk_mul_f32 v[34:35], v[34:35], v[66:67] op_sel_hi:[1,0]
    v_pk_mul_f32 v[80:81], v[80:81], v[68:69] op_sel_hi:[1,0]
    v_pk_mul_f32 v[82:83], v[82:83], v[68:69] op_sel_hi:[1,0]
    v_cvt_pk_bf16_f32 v48, v32, v33
    v_cvt_pk_bf16_f32 v49, v34, v35
    v_cvt_pk_bf16_f32 v50, v80, v81
    v_cvt_pk_bf16_f32 v51, v82, v83
    ds_write_b128 v1, v[48:51] offset:16384
    v_pk_mul_f32 v[36:37], v[36:37], v[66:67] op_sel_hi:[1,0]
    v_pk_mul_f32 v[38:39], v[38:39], v[66:67] op_sel_hi:[1,0]
    v_pk_mul_f32 v[84:85], v[84:85], v[68:69] op_sel_hi:[1,0]
    v_pk_mul_f32 v[86:87], v[86:87], v[68:69] op_sel_hi:[1,0]
    v_cvt_pk_bf16_f32 v52, v36, v37
    v_cvt_pk_bf16_f32 v53, v38, v39
    v_cvt_pk_bf16_f32 v54, v84, v85
    v_cvt_pk_bf16_f32 v55, v86, v87
    ds_write_b128 v2, v[52:55] offset:16384
    v_pk_mul_f32 v[40:41], v[40:41], v[66:67] op_sel_hi:[1,0]
    v_pk_mul_f32 v[42:43], v[42:43], v[66:67] op_sel_hi:[1,0]
    v_pk_mul_f32 v[88:89], v[88:89], v[68:69] op_sel_hi:[1,0]
    v_pk_mul_f32 v[90:91], v[90:91], v[68:69] op_sel_hi:[1,0]
    v_cvt_pk_bf16_f32 v56, v40, v41
    v_cvt_pk_bf16_f32 v57, v42, v43
    v_cvt_pk_bf16_f32 v58, v88, v89
    v_cvt_pk_bf16_f32 v59, v90, v91
    ds_write_b128 v3, v[56:59] offset:16384
    v_pk_mul_f32 v[44:45], v[44:45], v[66:67] op_sel_hi:[1,0]
    v_pk_mul_f32 v[46:47], v[46:47], v[66:67] op_sel_hi:[1,0]
    v_pk_mul_f32 v[92:93], v[92:93], v[68:69] op_sel_hi:[1,0]
    v_pk_mul_f32 v[94:95], v[94:95], v[68:69] op_sel_hi:[1,0]
    v_cvt_pk_bf16_f32 v60, v44, v45
    v_cvt_pk_bf16_f32 v61, v46, v47
    v_cvt_pk_bf16_f32 v62, v92, v93
    v_cvt_pk_bf16_f32 v63, v94, v95
    ds_write_b128 v4, v[60:63] offset:16384
    s_waitcnt lgkmcnt(0)
    s_barrier
    v_add_u32 v1, 53248, v6
    v_xor_b32 v2, 16, v1
    v_xor_b32 v3, 32, v1
    v_xor_b32 v4, 48, v1
    v_mov_b32 v64, v7
    ds_read_b128 v[16:19], v1 offset:0
    ds_read_b128 v[20:23], v2 offset:0
    ds_read_b128 v[24:27], v3 offset:0
    ds_read_b128 v[28:31], v4 offset:0
    ds_read_b128 v[80:83], v1 offset:16384
    ds_read_b128 v[84:87], v2 offset:16384
    ds_read_b128 v[88:91], v3 offset:16384
    ds_read_b128 v[92:95], v4 offset:16384
    s_waitcnt lgkmcnt(7)
    v_max3_f32 v66, v16, v17, v18
    v_min3_f32 v68, v16, v17, v18
    s_waitcnt lgkmcnt(6)
    v_max3_f32 v66, v66, v19, v20
    v_min3_f32 v68, v68, v19, v20
    v_max3_f32 v66, v66, v21, v22
    v_min3_f32 v68, v68, v21, v22
    s_waitcnt lgkmcnt(5)
    v_max3_f32 v66, v66, v23, v24
    v_min3_f32 v68, v68, v23, v24
    v_max3_f32 v66, v66, v25, v26
    v_min3_f32 v68, v68, v25, v26
    s_waitcnt lgkmcnt(4)
    v_max3_f32 v66, v66, v27, v28
    v_min3_f32 v68, v68, v27, v28
    v_max3_f32 v66, v66, v29, v30
    v_min3_f32 v68, v68, v29, v30
    v_max_f32 v66, v66, v31
    v_min_f32 v68, v68, v31
    v_mul_f32 v66, v66, v64
    v_mul_f32 v68, v68, v64
    v_pk_fma_f32 v[32:33], v[16:17], v[64:65], v[66:67] op_sel_hi:[1,0,0] neg_lo:[0,0,1] neg_hi:[0,0,1]
    v_pk_fma_f32 v[16:17], v[16:17], v[64:65], v[68:69] op_sel_hi:[1,0,0] neg_lo:[1,0,0] neg_hi:[1,0,0]
    v_pk_fma_f32 v[34:35], v[18:19], v[64:65], v[66:67] op_sel_hi:[1,0,0] neg_lo:[0,0,1] neg_hi:[0,0,1]
    v_pk_fma_f32 v[18:19], v[18:19], v[64:65], v[68:69] op_sel_hi:[1,0,0] neg_lo:[1,0,0] neg_hi:[1,0,0]
    v_pk_fma_f32 v[36:37], v[20:21], v[64:65], v[66:67] op_sel_hi:[1,0,0] neg_lo:[0,0,1] neg_hi:[0,0,1]
    v_pk_fma_f32 v[20:21], v[20:21], v[64:65], v[68:69] op_sel_hi:[1,0,0] neg_lo:[1,0,0] neg_hi:[1,0,0]
    v_pk_fma_f32 v[38:39], v[22:23], v[64:65], v[66:67] op_sel_hi:[1,0,0] neg_lo:[0,0,1] neg_hi:[0,0,1]
    v_pk_fma_f32 v[22:23], v[22:23], v[64:65], v[68:69] op_sel_hi:[1,0,0] neg_lo:[1,0,0] neg_hi:[1,0,0]
    v_pk_fma_f32 v[40:41], v[24:25], v[64:65], v[66:67] op_sel_hi:[1,0,0] neg_lo:[0,0,1] neg_hi:[0,0,1]
    v_pk_fma_f32 v[24:25], v[24:25], v[64:65], v[68:69] op_sel_hi:[1,0,0] neg_lo:[1,0,0] neg_hi:[1,0,0]
    v_pk_fma_f32 v[42:43], v[26:27], v[64:65], v[66:67] op_sel_hi:[1,0,0] neg_lo:[0,0,1] neg_hi:[0,0,1]
    v_pk_fma_f32 v[26:27], v[26:27], v[64:65], v[68:69] op_sel_hi:[1,0,0] neg_lo:[1,0,0] neg_hi:[1,0,0]
    v_pk_fma_f32 v[44:45], v[28:29], v[64:65], v[66:67] op_sel_hi:[1,0,0] neg_lo:[0,0,1] neg_hi:[0,0,1]
    v_pk_fma_f32 v[28:29], v[28:29], v[64:65], v[68:69] op_sel_hi:[1,0,0] neg_lo:[1,0,0] neg_hi:[1,0,0]
    v_pk_fma_f32 v[46:47], v[30:31], v[64:65], v[66:67] op_sel_hi:[1,0,0] neg_lo:[0,0,1] neg_hi:[0,0,1]
    v_pk_fma_f32 v[30:31], v[30:31], v[64:65], v[68:69] op_sel_hi:[1,0,0] neg_lo:[1,0,0] neg_hi:[1,0,0]
    v_exp_f32 v32, v32
    v_exp_f32 v16, v16
    v_exp_f32 v33, v33
    v_exp_f32 v17, v17
    v_exp_f32 v34, v34
    v_exp_f32 v18, v18
    v_exp_f32 v35, v35
    v_exp_f32 v19, v19
    v_exp_f32 v36, v36
    v_exp_f32 v20, v20
    v_exp_f32 v37, v37
    v_exp_f32 v21, v21
    v_exp_f32 v38, v38
    v_exp_f32 v22, v22
    v_exp_f32 v39, v39
    v_exp_f32 v23, v23
    v_exp_f32 v40, v40
    v_exp_f32 v24, v24
    s_waitcnt vmcnt(0)
    v_mov_b32 v96, 0
    v_mov_b32 v97, 1
    s_mov_b64 exec, 1
    ds_add_u32 v96, v97 offset:28
    s_mov_b64 exec, -1
    v_exp_f32 v41, v41
    v_exp_f32 v25, v25
    v_exp_f32 v42, v42
    v_exp_f32 v26, v26
    v_exp_f32 v43, v43
    v_exp_f32 v27, v27
    v_exp_f32 v44, v44
    v_exp_f32 v28, v28
    v_exp_f32 v45, v45
    v_exp_f32 v29, v29
    v_exp_f32 v46, v46
    v_exp_f32 v30, v30
    v_exp_f32 v47, v47
    v_exp_f32 v31, v31
    v_pk_add_f32 v[66:67], v[32:33], v[34:35]
    v_pk_add_f32 v[70:71], v[36:37], v[38:39]
    v_pk_add_f32 v[68:69], v[16:17], v[18:19]
    v_pk_add_f32 v[72:73], v[20:21], v[22:23]
    v_pk_add_f32 v[66:67], v[66:67], v[40:41]
    v_pk_add_f32 v[70:71], v[70:71], v[42:43]
    v_pk_add_f32 v[68:69], v[68:69], v[24:25]
    v_pk_add_f32 v[72:73], v[72:73], v[26:27]
    v_pk_add_f32 v[66:67], v[66:67], v[44:45]
    v_pk_add_f32 v[70:71], v[70:71], v[46:47]
    v_pk_add_f32 v[68:69], v[68:69], v[28:29]
    v_pk_add_f32 v[72:73], v[72:73], v[30:31]
    v_pk_add_f32 v[66:67], v[66:67], v[70:71]
    v_pk_add_f32 v[68:69], v[68:69], v[72:73]
    v_add_f32 v66, v66, v67
    v_add_f32 v68, v68, v69
    v_rcp_f32 v66, v66
    v_rcp_f32 v68, v68
    v_pk_mul_f32 v[32:33], v[32:33], v[66:67] op_sel_hi:[1,0]
    v_pk_mul_f32 v[34:35], v[34:35], v[66:67] op_sel_hi:[1,0]
    v_pk_mul_f32 v[16:17], v[16:17], v[68:69] op_sel_hi:[1,0]
    v_pk_mul_f32 v[18:19], v[18:19], v[68:69] op_sel_hi:[1,0]
    v_cvt_pk_bf16_f32 v48, v32, v33
    v_cvt_pk_bf16_f32 v49, v34, v35
    v_cvt_pk_bf16_f32 v50, v16, v17
    v_cvt_pk_bf16_f32 v51, v18, v19
    ds_write_b128 v1, v[48:51] offset:0
    v_pk_mul_f32 v[36:37], v[36:37], v[66:67] op_sel_hi:[1,0]
    v_pk_mul_f32 v[38:39], v[38:39], v[66:67] op_sel_hi:[1,0]
    v_pk_mul_f32 v[20:21], v[20:21], v[68:69] op_sel_hi:[1,0]
    v_pk_mul_f32 v[22:23], v[22:23], v[68:69] op_sel_hi:[1,0]
    v_cvt_pk_bf16_f32 v52, v36, v37
    v_cvt_pk_bf16_f32 v53, v38, v39
    v_cvt_pk_bf16_f32 v54, v20, v21
    v_cvt_pk_bf16_f32 v55, v22, v23
    ds_write_b128 v2, v[52:55] offset:0
    v_pk_mul_f32 v[40:41], v[40:41], v[66:67] op_sel_hi:[1,0]
    v_pk_mul_f32 v[42:43], v[42:43], v[66:67] op_sel_hi:[1,0]
    v_pk_mul_f32 v[24:25], v[24:25], v[68:69] op_sel_hi:[1,0]
    v_pk_mul_f32 v[26:27], v[26:27], v[68:69] op_sel_hi:[1,0]
    v_cvt_pk_bf16_f32 v56, v40, v41
    v_cvt_pk_bf16_f32 v57, v42, v43
    v_cvt_pk_bf16_f32 v58, v24, v25
    v_cvt_pk_bf16_f32 v59, v26, v27
    ds_write_b128 v3, v[56:59] offset:0
    v_pk_mul_f32 v[44:45], v[44:45], v[66:67] op_sel_hi:[1,0]
    v_pk_mul_f32 v[46:47], v[46:47], v[66:67] op_sel_hi:[1,0]
    v_pk_mul_f32 v[28:29], v[28:29], v[68:69] op_sel_hi:[1,0]
    v_pk_mul_f32 v[30:31], v[30:31], v[68:69] op_sel_hi:[1,0]
    v_cvt_pk_bf16_f32 v60, v44, v45
    v_cvt_pk_bf16_f32 v61, v46, v47
    v_cvt_pk_bf16_f32 v62, v28, v29
    v_cvt_pk_bf16_f32 v63, v30, v31
    ds_write_b128 v4, v[60:63] offset:0
    s_waitcnt lgkmcnt(8)
    v_max3_f32 v66, v80, v81, v82
    v_min3_f32 v68, v80, v81, v82
    s_waitcnt lgkmcnt(7)
    v_max3_f32 v66, v66, v83, v84
    v_min3_f32 v68, v68, v83, v84
    v_max3_f32 v66, v66, v85, v86
    v_min3_f32 v68, v68, v85, v86
    s_waitcnt lgkmcnt(6)
    v_max3_f32 v66, v66, v87, v88
    v_min3_f32 v68, v68, v87, v88
    v_max3_f32 v66, v66, v89, v90
    v_min3_f32 v68, v68, v89, v90
    s_waitcnt lgkmcnt(5)
    v_max3_f32 v66, v66, v91, v92
    v_min3_f32 v68, v68, v91, v92
    v_max3_f32 v66, v66, v93, v94
    v_min3_f32 v68, v68, v93, v94
    v_max_f32 v66, v66, v95
    v_min_f32 v68, v68, v95
    v_mul_f32 v66, v66, v64
    v_mul_f32 v68, v68, v64
    v_pk_fma_f32 v[32:33], v[80:81], v[64:65], v[66:67] op_sel_hi:[1,0,0] neg_lo:[0,0,1] neg_hi:[0,0,1]
    v_pk_fma_f32 v[80:81], v[80:81], v[64:65], v[68:69] op_sel_hi:[1,0,0] neg_lo:[1,0,0] neg_hi:[1,0,0]
    v_pk_fma_f32 v[34:35], v[82:83], v[64:65], v[66:67] op_sel_hi:[1,0,0] neg_lo:[0,0,1] neg_hi:[0,0,1]
    v_pk_fma_f32 v[82:83], v[82:83], v[64:65], v[68:69] op_sel_hi:[1,0,0] neg_lo:[1,0,0] neg_hi:[1,0,0]
    v_pk_fma_f32 v[36:37], v[84:85], v[64:65], v[66:67] op_sel_hi:[1,0,0] neg_lo:[0,0,1] neg_hi:[0,0,1]
    v_pk_fma_f32 v[84:85], v[84:85], v[64:65], v[68:69] op_sel_hi:[1,0,0] neg_lo:[1,0,0] neg_hi:[1,0,0]
    v_pk_fma_f32 v[38:39], v[86:87], v[64:65], v[66:67] op_sel_hi:[1,0,0] neg_lo:[0,0,1] neg_hi:[0,0,1]
    v_pk_fma_f32 v[86:87], v[86:87], v[64:65], v[68:69] op_sel_hi:[1,0,0] neg_lo:[1,0,0] neg_hi:[1,0,0]
    v_pk_fma_f32 v[40:41], v[88:89], v[64:65], v[66:67] op_sel_hi:[1,0,0] neg_lo:[0,0,1] neg_hi:[0,0,1]
    v_pk_fma_f32 v[88:89], v[88:89], v[64:65], v[68:69] op_sel_hi:[1,0,0] neg_lo:[1,0,0] neg_hi:[1,0,0]
    v_pk_fma_f32 v[42:43], v[90:91], v[64:65], v[66:67] op_sel_hi:[1,0,0] neg_lo:[0,0,1] neg_hi:[0,0,1]
    v_pk_fma_f32 v[90:91], v[90:91], v[64:65], v[68:69] op_sel_hi:[1,0,0] neg_lo:[1,0,0] neg_hi:[1,0,0]
    v_pk_fma_f32 v[44:45], v[92:93], v[64:65], v[66:67] op_sel_hi:[1,0,0] neg_lo:[0,0,1] neg_hi:[0,0,1]
    v_pk_fma_f32 v[92:93], v[92:93], v[64:65], v[68:69] op_sel_hi:[1,0,0] neg_lo:[1,0,0] neg_hi:[1,0,0]
    v_pk_fma_f32 v[46:47], v[94:95], v[64:65], v[66:67] op_sel_hi:[1,0,0] neg_lo:[0,0,1] neg_hi:[0,0,1]
    v_pk_fma_f32 v[94:95], v[94:95], v[64:65], v[68:69] op_sel_hi:[1,0,0] neg_lo:[1,0,0] neg_hi:[1,0,0]
    v_exp_f32 v32, v32
    v_exp_f32 v80, v80
    v_exp_f32 v33, v33
    v_exp_f32 v81, v81
    v_exp_f32 v34, v34
    v_exp_f32 v82, v82
    v_exp_f32 v35, v35
    v_exp_f32 v83, v83
    v_exp_f32 v36, v36
    v_exp_f32 v84, v84
    v_exp_f32 v37, v37
    v_exp_f32 v85, v85
    v_exp_f32 v38, v38
    v_exp_f32 v86, v86
    v_exp_f32 v39, v39
    v_exp_f32 v87, v87
    v_exp_f32 v40, v40
    v_exp_f32 v88, v88
    v_exp_f32 v41, v41
    v_exp_f32 v89, v89
    v_exp_f32 v42, v42
    v_exp_f32 v90, v90
    v_exp_f32 v43, v43
    v_exp_f32 v91, v91
    v_exp_f32 v44, v44
    v_exp_f32 v92, v92
    v_exp_f32 v45, v45
    v_exp_f32 v93, v93
    v_exp_f32 v46, v46
    v_exp_f32 v94, v94
    v_exp_f32 v47, v47
    v_exp_f32 v95, v95
    v_pk_add_f32 v[66:67], v[32:33], v[34:35]
    v_pk_add_f32 v[70:71], v[36:37], v[38:39]
    v_pk_add_f32 v[68:69], v[80:81], v[82:83]
    v_pk_add_f32 v[72:73], v[84:85], v[86:87]
    v_pk_add_f32 v[66:67], v[66:67], v[40:41]
    v_pk_add_f32 v[70:71], v[70:71], v[42:43]
    v_pk_add_f32 v[68:69], v[68:69], v[88:89]
    v_pk_add_f32 v[72:73], v[72:73], v[90:91]
    v_pk_add_f32 v[66:67], v[66:67], v[44:45]
    v_pk_add_f32 v[70:71], v[70:71], v[46:47]
    v_pk_add_f32 v[68:69], v[68:69], v[92:93]
    v_pk_add_f32 v[72:73], v[72:73], v[94:95]
    v_pk_add_f32 v[66:67], v[66:67], v[70:71]
    v_pk_add_f32 v[68:69], v[68:69], v[72:73]
    v_add_f32 v66, v66, v67
    v_add_f32 v68, v68, v69
    v_rcp_f32 v66, v66
    v_rcp_f32 v68, v68
    v_pk_mul_f32 v[32:33], v[32:33], v[66:67] op_sel_hi:[1,0]
    v_pk_mul_f32 v[34:35], v[34:35], v[66:67] op_sel_hi:[1,0]
    v_pk_mul_f32 v[80:81], v[80:81], v[68:69] op_sel_hi:[1,0]
    v_pk_mul_f32 v[82:83], v[82:83], v[68:69] op_sel_hi:[1,0]
    v_cvt_pk_bf16_f32 v48, v32, v33
    v_cvt_pk_bf16_f32 v49, v34, v35
    v_cvt_pk_bf16_f32 v50, v80, v81
    v_cvt_pk_bf16_f32 v51, v82, v83
    ds_write_b128 v1, v[48:51] offset:16384
    v_pk_mul_f32 v[36:37], v[36:37], v[66:67] op_sel_hi:[1,0]
    v_pk_mul_f32 v[38:39], v[38:39], v[66:67] op_sel_hi:[1,0]
    v_pk_mul_f32 v[84:85], v[84:85], v[68:69] op_sel_hi:[1,0]
    v_pk_mul_f32 v[86:87], v[86:87], v[68:69] op_sel_hi:[1,0]
    v_cvt_pk_bf16_f32 v52, v36, v37
    v_cvt_pk_bf16_f32 v53, v38, v39
    v_cvt_pk_bf16_f32 v54, v84, v85
    v_cvt_pk_bf16_f32 v55, v86, v87
    ds_write_b128 v2, v[52:55] offset:16384
    v_pk_mul_f32 v[40:41], v[40:41], v[66:67] op_sel_hi:[1,0]
    v_pk_mul_f32 v[42:43], v[42:43], v[66:67] op_sel_hi:[1,0]
    v_pk_mul_f32 v[88:89], v[88:89], v[68:69] op_sel_hi:[1,0]
    v_pk_mul_f32 v[90:91], v[90:91], v[68:69] op_sel_hi:[1,0]
    v_cvt_pk_bf16_f32 v56, v40, v41
    v_cvt_pk_bf16_f32 v57, v42, v43
    v_cvt_pk_bf16_f32 v58, v88, v89
    v_cvt_pk_bf16_f32 v59, v90, v91
    ds_write_b128 v3, v[56:59] offset:16384
    v_pk_mul_f32 v[44:45], v[44:45], v[66:67] op_sel_hi:[1,0]
    v_pk_mul_f32 v[46:47], v[46:47], v[66:67] op_sel_hi:[1,0]
    v_pk_mul_f32 v[92:93], v[92:93], v[68:69] op_sel_hi:[1,0]
    v_pk_mul_f32 v[94:95], v[94:95], v[68:69] op_sel_hi:[1,0]
    v_cvt_pk_bf16_f32 v60, v44, v45
    v_cvt_pk_bf16_f32 v61, v46, v47
    v_cvt_pk_bf16_f32 v62, v92, v93
    v_cvt_pk_bf16_f32 v63, v94, v95
    ds_write_b128 v4, v[60:63] offset:16384
    s_waitcnt lgkmcnt(0)
    v_mov_b32 v66, 0
    v_mov_b32 v67, 1
    s_mov_b64 exec, 1
    ds_add_u32 v66, v67 offset:128
    s_mov_b64 exec, -1
    v_mov_b32 v66, 0
    v_mov_b32 v67, 1
    s_mov_b64 exec, 1
    ds_add_u32 v66, v67 offset:136
    s_mov_b64 exec, -1
    v_lshlrev_b32 v3, 2, v0
    s_lshr_b32 s69, s58, 1
    s_lshl_b32 s69, s69, 8
    s_add_u32 s69, s69, 0x909000
    s_lshl_b32 s64, s60, 3
    s_lshr_b32 s65, 0x4080804, s64
    s_lshr_b32 s66, 0x1c181414, s64
    s_bfm_b32 s67, s65, s66
    buffer_load_dword v4, v3, s[40:43], s69 offen sc1
    s_lshl_b32 s64, s58, 6
    s_lshl_b32 s65, s60, 4
    s_add_u32 s64, s64, s65
    s_lshl_b32 s64, s64, 10
    s_lshl_b32 s65, s59, 7
    s_add_u32 s64, s64, s65
    v_and_b32 v5, 15, v0
    v_lshlrev_b32 v5, 10, v5
    v_and_b32 v12, 48, v0
    v_add3_u32 v5, v5, v12, s64
    v_lshlrev_b32 v1, 4, v0
    s_mul_i32 s19, s58, 288
    s_add_u32 s19, s19, s23
    s_add_u32 s19, s19, 0
    s_lshl_b32 s19, s19, 10
    s_xor_b32 s64, s58, 1
    s_mul_i32 s68, s64, 288
    s_add_u32 s68, s68, s23
    s_lshl_b32 s68, s68, 10
    s_lshl_b32 s16, s64, 3
    s_add_u32 s16, s16, s59
    s_lshl_b32 s16, s16, 14
    s_lshl_b32 s65, s60, 12
    s_add_u32 s16, s16, s65
    s_add_u32 s16, s16, 11534336
    s_and_b32 s64, s64, 1
    s_lshl_b32 s64, s64, 5
    s_lshl_b32 s65, s59, 2
    s_add_u32 s64, s64, s65
    s_add_u32 s64, s64, s60
    s_lshl_b32 s64, s64, 2
    s_lshr_b32 s65, s58, 1
    s_lshl_b32 s65, s65, 8
    s_add_u32 s17, s64, s65
    s_add_u32 s17, s17, 9478144
    s_lshl_b32 s64, s60, 14
    s_add_u32 s64, s64, 94208
    v_add_u32 v96, s64, v1
    s_and_b32 s64, s58, 1
    s_lshl_b32 s64, s64, 5
    s_lshl_b32 s65, s59, 2
    s_add_u32 s64, s64, s65
    s_mov_b32 s65, s60
    s_add_u32 s64, s64, s65
    s_lshl_b32 s64, s64, 2
    s_lshr_b32 s66, s58, 1
    s_lshl_b32 s66, s66, 8
    s_add_u32 s10, s64, s66
    s_add_u32 s10, s10, 9478144
    s_lshl_b32 s11, s58, 3
    s_add_u32 s11, s11, s59
    s_lshl_b32 s11, s11, 14
    s_lshl_b32 s65, s65, 12
    s_add_u32 s11, s11, s65
    s_add_u32 s11, s11, 11534336
    v_mov_b32 v6, 0
    v_add_u32 v2, s21, v1
    s_mov_b32 s70, 40000
    s_waitcnt vmcnt(0)
    s_branch FPC_19
FP_17:
    buffer_load_dword v4, v3, s[40:43], s69 offen sc1
    s_waitcnt vmcnt(0)
FPC_19:
    v_cmp_eq_u32 vcc, s62, v4
    s_nop 0
    s_and_b32 s71, vcc_hi, s67
    s_cmp_eq_u32 s71, s67
    s_cbranch_scc1 FPD_18
    s_sub_u32 s70, s70, 1
    s_cbranch_scc1 FPD_18
    s_sleep 1
    s_branch FP_17
FPD_18:
    s_add_u32 s64, s68, 0
    buffer_load_dwordx4 v[16:19], v1, s[40:43], s64 offen offset:0 sc1
    s_add_u32 s64, s68, 0
    buffer_load_dwordx4 v[20:23], v1, s[40:43], s64 offen offset:1024 sc1
    s_add_u32 s64, s68, 0
    buffer_load_dwordx4 v[24:27], v1, s[40:43], s64 offen offset:2048 sc1
    s_add_u32 s64, s68, 0
    buffer_load_dwordx4 v[28:31], v1, s[40:43], s64 offen offset:3072 sc1
    s_add_u32 s64, s68, 4096
    buffer_load_dwordx4 v[32:35], v1, s[40:43], s64 offen offset:0 sc1
    s_add_u32 s64, s68, 73728
    buffer_load_dwordx4 v[36:39], v1, s[40:43], s64 offen offset:0 sc1
    s_add_u32 s64, s68, 73728
    buffer_load_dwordx4 v[40:43], v1, s[40:43], s64 offen offset:1024 sc1
    s_add_u32 s64, s68, 73728
    buffer_load_dwordx4 v[44:47], v1, s[40:43], s64 offen offset:2048 sc1
    s_add_u32 s64, s68, 73728
    buffer_load_dwordx4 v[48:51], v1, s[40:43], s64 offen offset:3072 sc1
    s_add_u32 s64, s68, 77824
    buffer_load_dwordx4 v[52:55], v1, s[40:43], s64 offen offset:0 sc1
    s_add_u32 s64, s68, 147456
    buffer_load_dwordx4 v[56:59], v1, s[40:43], s64 offen offset:0 sc1
    s_add_u32 s64, s68, 147456
    buffer_load_dwordx4 v[60:63], v1, s[40:43], s64 offen offset:1024 sc1
    s_waitcnt vmcnt(11)
    v_mfma_f32_16x16x32_bf16 v[64:67], v[112:115], v[16:19], 0
    v_mfma_f32_16x16x32_bf16 v[68:71], v[116:119], v[16:19], 0
    v_mfma_f32_16x16x32_bf16 v[72:75], v[120:123], v[16:19], 0
    v_mfma_f32_16x16x32_bf16 v[76:79], v[124:127], v[16:19], 0
    s_add_u32 s64, s68, 147456
    buffer_load_dwordx4 v[16:19], v1, s[40:43], s64 offen offset:2048 sc1
    s_waitcnt vmcnt(11)
    v_mfma_f32_16x16x32_bf16 v[64:67], v[128:131], v[20:23], v[64:67]
    v_mfma_f32_16x16x32_bf16 v[68:71], v[132:135], v[20:23], v[68:71]
    v_mfma_f32_16x16x32_bf16 v[72:75], v[136:139], v[20:23], v[72:75]
    v_mfma_f32_16x16x32_bf16 v[76:79], v[140:143], v[20:23], v[76:79]
    s_add_u32 s64, s68, 147456
    buffer_load_dwordx4 v[20:23], v1, s[40:43], s64 offen offset:3072 sc1
    s_waitcnt vmcnt(11)
    v_mfma_f32_16x16x32_bf16 v[64:67], v[144:147], v[24:27], v[64:67]
    v_mfma_f32_16x16x32_bf16 v[68:71], v[148:151], v[24:27], v[68:71]
    v_mfma_f32_16x16x32_bf16 v[72:75], v[152:155], v[24:27], v[72:75]
    v_mfma_f32_16x16x32_bf16 v[76:79], v[156:159], v[24:27], v[76:79]
    s_add_u32 s64, s68, 151552
    buffer_load_dwordx4 v[24:27], v1, s[40:43], s64 offen offset:0 sc1
    s_waitcnt vmcnt(11)
    v_mfma_f32_16x16x32_bf16 v[64:67], v[160:163], v[28:31], v[64:67]
    v_mfma_f32_16x16x32_bf16 v[68:71], v[164:167], v[28:31], v[68:71]
    v_mfma_f32_16x16x32_bf16 v[72:75], v[168:171], v[28:31], v[72:75]
    v_mfma_f32_16x16x32_bf16 v[76:79], v[172:175], v[28:31], v[76:79]
    s_add_u32 s64, s68, 221184
    buffer_load_dwordx4 v[28:31], v1, s[40:43], s64 offen offset:0 sc1
    s_waitcnt vmcnt(11)
    v_mfma_f32_16x16x32_bf16 v[64:67], v[176:179], v[32:35], v[64:67]
    v_mfma_f32_16x16x32_bf16 v[68:71], v[180:183], v[32:35], v[68:71]
    v_mfma_f32_16x16x32_bf16 v[72:75], v[184:187], v[32:35], v[72:75]
    v_mfma_f32_16x16x32_bf16 v[76:79], v[188:191], v[32:35], v[76:79]
    s_add_u32 s64, s68, 221184
    buffer_load_dwordx4 v[32:35], v1, s[40:43], s64 offen offset:1024 sc1
    s_waitcnt vmcnt(11)
    v_mfma_f32_16x16x32_bf16 v[80:83], v[112:115], v[36:39], 0
    v_mfma_f32_16x16x32_bf16 v[84:87], v[116:119], v[36:39], 0
    v_mfma_f32_16x16x32_bf16 v[88:91], v[120:123], v[36:39], 0
    v_mfma_f32_16x16x32_bf16 v[92:95], v[124:127], v[36:39], 0
    s_lshl_b32 s65, s60, 2
    s_mov_b32 s70, 40000
    v_mov_b32 v98, s65
CW_20:
    ds_read_b32 v99, v98 offset:32
    s_waitcnt lgkmcnt(0)
    v_readfirstlane_b32 s71, v99
    s_nop 0
    s_cmp_ge_u32 s71, 1
    s_cbranch_scc1 CWD_21
    s_sub_u32 s70, s70, 1
    s_cbranch_scc1 CWD_21
    s_sleep 1
    s_branch CW_20
CWD_21:
    ds_write_b128 v2, v[64:67] offset:0
    s_add_u32 s64, s68, 221184
    buffer_load_dwordx4 v[36:39], v1, s[40:43], s64 offen offset:2048 sc1
    s_waitcnt vmcnt(11)
    v_mfma_f32_16x16x32_bf16 v[80:83], v[128:131], v[40:43], v[80:83]
    v_mfma_f32_16x16x32_bf16 v[84:87], v[132:135], v[40:43], v[84:87]
    v_mfma_f32_16x16x32_bf16 v[88:91], v[136:139], v[40:43], v[88:91]
    v_mfma_f32_16x16x32_bf16 v[92:95], v[140:143], v[40:43], v[92:95]
    ds_write_b128 v2, v[68:71] offset:1024
    ds_write_b128 v2, v[72:75] offset:2048
    s_add_u32 s64, s68, 221184
    buffer_load_dwordx4 v[40:43], v1, s[40:43], s64 offen offset:3072 sc1
    s_waitcnt vmcnt(11)
    v_mfma_f32_16x16x32_bf16 v[80:83], v[144:147], v[44:47], v[80:83]
    v_mfma_f32_16x16x32_bf16 v[84:87], v[148:151], v[44:47], v[84:87]
    v_mfma_f32_16x16x32_bf16 v[88:91], v[152:155], v[44:47], v[88:91]
    v_mfma_f32_16x16x32_bf16 v[92:95], v[156:159], v[44:47], v[92:95]
    ds_write_b128 v2, v[76:79] offset:3072
    v_mov_b32 v98, 0
    v_mov_b32 v99, 1
    s_mov_b64 exec, 1
    ds_add_u32 v98, v99 offset:48
    s_mov_b64 exec, -1
    s_add_u32 s64, s68, 225280
    buffer_load_dwordx4 v[44:47], v1, s[40:43], s64 offen offset:0 sc1
    s_waitcnt vmcnt(11)
    v_mfma_f32_16x16x32_bf16 v[80:83], v[160:163], v[48:51], v[80:83]
    v_mfma_f32_16x16x32_bf16 v[84:87], v[164:167], v[48:51], v[84:87]
    v_mfma_f32_16x16x32_bf16 v[88:91], v[168:171], v[48:51], v[88:91]
    v_mfma_f32_16x16x32_bf16 v[92:95], v[172:175], v[48:51], v[92:95]
    s_add_u32 s64, s19, 0
    buffer_load_dwordx4 v[48:51], v1, s[40:43], s64 offen offset:0 sc1
    s_waitcnt vmcnt(11)
    v_mfma_f32_16x16x32_bf16 v[80:83], v[176:179], v[52:55], v[80:83]
    v_mfma_f32_16x16x32_bf16 v[84:87], v[180:183], v[52:55], v[84:87]
    v_mfma_f32_16x16x32_bf16 v[88:91], v[184:187], v[52:55], v[88:91]
    v_mfma_f32_16x16x32_bf16 v[92:95], v[188:191], v[52:55], v[92:95]
    s_add_u32 s64, s19, 0
    buffer_load_dwordx4 v[52:55], v1, s[40:43], s64 offen offset:1024 sc1
    s_waitcnt vmcnt(11)
    v_mfma_f32_16x16x32_bf16 v[64:67], v[112:115], v[56:59], 0
    v_mfma_f32_16x16x32_bf16 v[68:71], v[116:119], v[56:59], 0
    v_mfma_f32_16x16x32_bf16 v[72:75], v[120:123], v[56:59], 0
    v_mfma_f32_16x16x32_bf16 v[76:79], v[124:127], v[56:59], 0
    ds_write_b128 v2, v[80:83] offset:16384
    ds_write_b128 v2, v[84:87] offset:17408
    s_add_u32 s64, s19, 0
    buffer_load_dwordx4 v[56:59], v1, s[40:43], s64 offen offset:2048 sc1
    s_waitcnt vmcnt(11)
    v_mfma_f32_16x16x32_bf16 v[64:67], v[128:131], v[60:63], v[64:67]
    v_mfma_f32_16x16x32_bf16 v[68:71], v[132:135], v[60:63], v[68:71]
    v_mfma_f32_16x16x32_bf16 v[72:75], v[136:139], v[60:63], v[72:75]
    v_mfma_f32_16x16x32_bf16 v[76:79], v[140:143], v[60:63], v[76:79]
    ds_write_b128 v2, v[88:91] offset:18432
    ds_write_b128 v2, v[92:95] offset:19456
    s_add_u32 s64, s19, 0
    buffer_load_dwordx4 v[60:63], v1, s[40:43], s64 offen offset:3072 sc1
    s_waitcnt vmcnt(11)
    v_mfma_f32_16x16x32_bf16 v[64:67], v[144:147], v[16:19], v[64:67]
    v_mfma_f32_16x16x32_bf16 v[68:71], v[148:151], v[16:19], v[68:71]
    v_mfma_f32_16x16x32_bf16 v[72:75], v[152:155], v[16:19], v[72:75]
    v_mfma_f32_16x16x32_bf16 v[76:79], v[156:159], v[16:19], v[76:79]
    v_mov_b32 v98, 0
    v_mov_b32 v99, 1
    s_mov_b64 exec, 1
    ds_add_u32 v98, v99 offset:52
    s_mov_b64 exec, -1
    s_add_u32 s64, s19, 4096
    buffer_load_dwordx4 v[16:19], v1, s[40:43], s64 offen offset:0 sc1
    s_waitcnt vmcnt(11)
    v_mfma_f32_16x16x32_bf16 v[64:67], v[160:163], v[20:23], v[64:67]
    v_mfma_f32_16x16x32_bf16 v[68:71], v[164:167], v[20:23], v[68:71]
    v_mfma_f32_16x16x32_bf16 v[72:75], v[168:171], v[20:23], v[72:75]
    v_mfma_f32_16x16x32_bf16 v[76:79], v[172:175], v[20:23], v[76:79]
    s_add_u32 s64, s19, 73728
    buffer_load_dwordx4 v[20:23], v1, s[40:43], s64 offen offset:0 sc1
    s_waitcnt vmcnt(11)
    v_mfma_f32_16x16x32_bf16 v[64:67], v[176:179], v[24:27], v[64:67]
    v_mfma_f32_16x16x32_bf16 v[68:71], v[180:183], v[24:27], v[68:71]
    v_mfma_f32_16x16x32_bf16 v[72:75], v[184:187], v[24:27], v[72:75]
    v_mfma_f32_16x16x32_bf16 v[76:79], v[188:191], v[24:27], v[76:79]
    s_add_u32 s64, s19, 73728
    buffer_load_dwordx4 v[24:27], v1, s[40:43], s64 offen offset:1024 sc1
    s_waitcnt vmcnt(11)
    v_mfma_f32_16x16x32_bf16 v[80:83], v[112:115], v[28:31], 0
    v_mfma_f32_16x16x32_bf16 v[84:87], v[116:119], v[28:31], 0
    v_mfma_f32_16x16x32_bf16 v[88:91], v[120:123], v[28:31], 0
    v_mfma_f32_16x16x32_bf16 v[92:95], v[124:127], v[28:31], 0
    ds_write_b128 v2, v[64:67] offset:32768
    ds_write_b128 v2, v[68:71] offset:33792
    s_add_u32 s64, s19, 73728
    buffer_load_dwordx4 v[28:31], v1, s[40:43], s64 offen offset:2048 sc1
    s_waitcnt vmcnt(11)
    v_mfma_f32_16x16x32_bf16 v[80:83], v[128:131], v[32:35], v[80:83]
    v_mfma_f32_16x16x32_bf16 v[84:87], v[132:135], v[32:35], v[84:87]
    v_mfma_f32_16x16x32_bf16 v[88:91], v[136:139], v[32:35], v[88:91]
    v_mfma_f32_16x16x32_bf16 v[92:95], v[140:143], v[32:35], v[92:95]
    ds_write_b128 v2, v[72:75] offset:34816
    ds_write_b128 v2, v[76:79] offset:35840
    s_add_u32 s64, s19, 73728
    buffer_load_dwordx4 v[32:35], v1, s[40:43], s64 offen offset:3072 sc1
    s_waitcnt vmcnt(11)
    v_mfma_f32_16x16x32_bf16 v[80:83], v[144:147], v[36:39], v[80:83]
    v_mfma_f32_16x16x32_bf16 v[84:87], v[148:151], v[36:39], v[84:87]
    v_mfma_f32_16x16x32_bf16 v[88:91], v[152:155], v[36:39], v[88:91]
    v_mfma_f32_16x16x32_bf16 v[92:95], v[156:159], v[36:39], v[92:95]
    v_mov_b32 v98, 0
    v_mov_b32 v99, 1
    s_mov_b64 exec, 1
    ds_add_u32 v98, v99 offset:56
    s_mov_b64 exec, -1
    s_add_u32 s64, s19, 77824
    buffer_load_dwordx4 v[36:39], v1, s[40:43], s64 offen offset:0 sc1
    s_waitcnt vmcnt(11)
    v_mfma_f32_16x16x32_bf16 v[80:83], v[160:163], v[40:43], v[80:83]
    v_mfma_f32_16x16x32_bf16 v[84:87], v[164:167], v[40:43], v[84:87]
    v_mfma_f32_16x16x32_bf16 v[88:91], v[168:171], v[40:43], v[88:91]
    v_mfma_f32_16x16x32_bf16 v[92:95], v[172:175], v[40:43], v[92:95]
    s_add_u32 s64, s19, 147456
    buffer_load_dwordx4 v[40:43], v1, s[40:43], s64 offen offset:0 sc1
    s_waitcnt vmcnt(11)
    v_mfma_f32_16x16x32_bf16 v[80:83], v[176:179], v[44:47], v[80:83]
    v_mfma_f32_16x16x32_bf16 v[84:87], v[180:183], v[44:47], v[84:87]
    v_mfma_f32_16x16x32_bf16 v[88:91], v[184:187], v[44:47], v[88:91]
    v_mfma_f32_16x16x32_bf16 v[92:95], v[188:191], v[44:47], v[92:95]
    s_add_u32 s64, s19, 147456
    buffer_load_dwordx4 v[44:47], v1, s[40:43], s64 offen offset:1024 sc1
    s_waitcnt vmcnt(11)
    v_mfma_f32_16x16x32_bf16 v[64:67], v[112:115], v[48:51], 0
    v_mfma_f32_16x16x32_bf16 v[68:71], v[116:119], v[48:51], 0
    v_mfma_f32_16x16x32_bf16 v[72:75], v[120:123], v[48:51], 0
    v_mfma_f32_16x16x32_bf16 v[76:79], v[124:127], v[48:51], 0
    ds_write_b128 v2, v[80:83] offset:49152
    ds_write_b128 v2, v[84:87] offset:50176
    ds_write_b128 v2, v[88:91] offset:51200
    ds_write_b128 v2, v[92:95] offset:52224
    v_mov_b32 v98, 0
    v_mov_b32 v99, 1
    s_mov_b64 exec, 1
    ds_add_u32 v98, v99 offset:60
    s_mov_b64 exec, -1
    s_add_u32 s64, s19, 147456
    buffer_load_dwordx4 v[48:51], v1, s[40:43], s64 offen offset:2048 sc1
    s_lshl_b32 s65, s60, 2
    s_mov_b32 s70, 40000
    v_mov_b32 v98, s65
CW_22:
    ds_read_b32 v99, v98 offset:48
    s_waitcnt lgkmcnt(0)
    v_readfirstlane_b32 s71, v99
    s_nop 0
    s_cmp_ge_u32 s71, 4
    s_cbranch_scc1 CWD_23
    s_sub_u32 s70, s70, 1
    s_cbranch_scc1 CWD_23
    s_sleep 1
    s_branch CW_22
CWD_23:
    ds_read_b128 v[80:83], v96 offset:0
    ds_read_b128 v[84:87], v96 offset:4096
    ds_read_b128 v[88:91], v96 offset:8192
    ds_read_b128 v[92:95], v96 offset:12288
    s_waitcnt vmcnt(11)
    v_mfma_f32_16x16x32_bf16 v[64:67], v[128:131], v[52:55], v[64:67]
    v_mfma_f32_16x16x32_bf16 v[68:71], v[132:135], v[52:55], v[68:71]
    v_mfma_f32_16x16x32_bf16 v[72:75], v[136:139], v[52:55], v[72:75]
    v_mfma_f32_16x16x32_bf16 v[76:79], v[140:143], v[52:55], v[76:79]
    s_add_u32 s64, s19, 147456
    buffer_load_dwordx4 v[52:55], v1, s[40:43], s64 offen offset:3072 sc1
    s_waitcnt lgkmcnt(0)
    v_pk_add_f32 v[80:81], v[80:81], v[84:85]
    v_pk_add_f32 v[88:89], v[88:89], v[92:93]
    v_pk_add_f32 v[82:83], v[82:83], v[86:87]
    v_pk_add_f32 v[90:91], v[90:91], v[94:95]
    v_pk_add_f32 v[108:109], v[80:81], v[88:89]
    v_pk_add_f32 v[110:111], v[82:83], v[90:91]
    buffer_store_dwordx4 v[108:111], v1, s[40:43], s16 offen offset:0 sc1
    ds_read_b128 v[80:83], v96 offset:1024
    ds_read_b128 v[84:87], v96 offset:5120
    ds_read_b128 v[88:91], v96 offset:9216
    ds_read_b128 v[92:95], v96 offset:13312
    s_waitcnt vmcnt(12)
    v_mfma_f32_16x16x32_bf16 v[64:67], v[144:147], v[56:59], v[64:67]
    v_mfma_f32_16x16x32_bf16 v[68:71], v[148:151], v[56:59], v[68:71]
    v_mfma_f32_16x16x32_bf16 v[72:75], v[152:155], v[56:59], v[72:75]
    v_mfma_f32_16x16x32_bf16 v[76:79], v[156:159], v[56:59], v[76:79]
    s_add_u32 s64, s19, 151552
    buffer_load_dwordx4 v[56:59], v1, s[40:43], s64 offen offset:0 sc1
    s_waitcnt lgkmcnt(0)
    v_pk_add_f32 v[80:81], v[80:81], v[84:85]
    v_pk_add_f32 v[88:89], v[88:89], v[92:93]
    v_pk_add_f32 v[82:83], v[82:83], v[86:87]
    v_pk_add_f32 v[90:91], v[90:91], v[94:95]
    v_pk_add_f32 v[104:105], v[80:81], v[88:89]
    v_pk_add_f32 v[106:107], v[82:83], v[90:91]
    buffer_store_dwordx4 v[104:107], v1, s[40:43], s16 offen offset:1024 sc1
    ds_read_b128 v[80:83], v96 offset:2048
    ds_read_b128 v[84:87], v96 offset:6144
    ds_read_b128 v[88:91], v96 offset:10240
    ds_read_b128 v[92:95], v96 offset:14336
    s_waitcnt vmcnt(13)
    v_mfma_f32_16x16x32_bf16 v[64:67], v[160:163], v[60:63], v[64:67]
    v_mfma_f32_16x16x32_bf16 v[68:71], v[164:167], v[60:63], v[68:71]
    v_mfma_f32_16x16x32_bf16 v[72:75], v[168:171], v[60:63], v[72:75]
    v_mfma_f32_16x16x32_bf16 v[76:79], v[172:175], v[60:63], v[76:79]
    s_add_u32 s64, s19, 221184
    buffer_load_dwordx4 v[60:63], v1, s[40:43], s64 offen offset:0 sc1
    s_waitcnt lgkmcnt(0)
    v_pk_add_f32 v[80:81], v[80:81], v[84:85]
    v_pk_add_f32 v[88:89], v[88:89], v[92:93]
    v_pk_add_f32 v[82:83], v[82:83], v[86:87]
    v_pk_add_f32 v[90:91], v[90:91], v[94:95]
    v_pk_add_f32 v[108:109], v[80:81], v[88:89]
    v_pk_add_f32 v[110:111], v[82:83], v[90:91]
    buffer_store_dwordx4 v[108:111], v1, s[40:43], s16 offen offset:2048 sc1
    ds_read_b128 v[80:83], v96 offset:3072
    ds_read_b128 v[84:87], v96 offset:7168
    ds_read_b128 v[88:91], v96 offset:11264
    ds_read_b128 v[92:95], v96 offset:15360
    s_waitcnt vmcnt(14)
    v_mfma_f32_16x16x32_bf16 v[64:67], v[176:179], v[16:19], v[64:67]
    v_mfma_f32_16x16x32_bf16 v[68:71], v[180:183], v[16:19], v[68:71]
    v_mfma_f32_16x16x32_bf16 v[72:75], v[184:187], v[16:19], v[72:75]
    v_mfma_f32_16x16x32_bf16 v[76:79], v[188:191], v[16:19], v[76:79]
    s_add_u32 s64, s19, 221184
    buffer_load_dwordx4 v[16:19], v1, s[40:43], s64 offen offset:1024 sc1
    s_waitcnt lgkmcnt(0)
    v_mov_b32 v98, 0
    v_mov_b32 v99, 1
    s_mov_b64 exec, 1
    ds_add_u32 v98, v99 offset:12
    s_mov_b64 exec, -1
    v_pk_add_f32 v[80:81], v[80:81], v[84:85]
    v_pk_add_f32 v[88:89], v[88:89], v[92:93]
    v_pk_add_f32 v[82:83], v[82:83], v[86:87]
    v_pk_add_f32 v[90:91], v[90:91], v[94:95]
    v_pk_add_f32 v[104:105], v[80:81], v[88:89]
    v_pk_add_f32 v[106:107], v[82:83], v[90:91]
    buffer_store_dwordx4 v[104:107], v1, s[40:43], s16 offen offset:3072 sc1
    s_waitcnt vmcnt(15)
    v_mfma_f32_16x16x32_bf16 v[80:83], v[112:115], v[20:23], 0
    v_mfma_f32_16x16x32_bf16 v[84:87], v[116:119], v[20:23], 0
    v_mfma_f32_16x16x32_bf16 v[88:91], v[120:123], v[20:23], 0
    v_mfma_f32_16x16x32_bf16 v[92:95], v[124:127], v[20:23], 0
    s_mov_b32 s70, 40000
    v_mov_b32 v98, 0
CW_24:
    ds_read_b32 v99, v98 offset:12
    s_waitcnt lgkmcnt(0)
    v_readfirstlane_b32 s71, v99
    s_nop 0
    s_cmp_ge_u32 s71, 4
    s_cbranch_scc1 CWD_25
    s_sub_u32 s70, s70, 1
    s_cbranch_scc1 CWD_25
    s_sleep 1
    s_branch CW_24
CWD_25:
    ds_write_b128 v2, v[64:67] offset:0
    s_add_u32 s64, s19, 221184
    buffer_load_dwordx4 v[20:23], v1, s[40:43], s64 offen offset:2048 sc1
    s_waitcnt vmcnt(15)
    v_mfma_f32_16x16x32_bf16 v[80:83], v[128:131], v[24:27], v[80:83]
    v_mfma_f32_16x16x32_bf16 v[84:87], v[132:135], v[24:27], v[84:87]
    v_mfma_f32_16x16x32_bf16 v[88:91], v[136:139], v[24:27], v[88:91]
    v_mfma_f32_16x16x32_bf16 v[92:95], v[140:143], v[24:27], v[92:95]
    ds_write_b128 v2, v[68:71] offset:1024
    ds_write_b128 v2, v[72:75] offset:2048
    s_add_u32 s64, s19, 221184
    buffer_load_dwordx4 v[24:27], v1, s[40:43], s64 offen offset:3072 sc1
    s_waitcnt vmcnt(15)
    v_mfma_f32_16x16x32_bf16 v[80:83], v[144:147], v[28:31], v[80:83]
    v_mfma_f32_16x16x32_bf16 v[84:87], v[148:151], v[28:31], v[84:87]
    v_mfma_f32_16x16x32_bf16 v[88:91], v[152:155], v[28:31], v[88:91]
    v_mfma_f32_16x16x32_bf16 v[92:95], v[156:159], v[28:31], v[92:95]
    ds_write_b128 v2, v[76:79] offset:3072
    v_mov_b32 v98, 0
    v_mov_b32 v99, 1
    s_mov_b64 exec, 1
    ds_add_u32 v98, v99 offset:48
    s_mov_b64 exec, -1
    s_add_u32 s64, s19, 225280
    buffer_load_dwordx4 v[28:31], v1, s[40:43], s64 offen offset:0 sc1
    buffer_load_dword v7, v6, s[40:43], s10 offen sc1
    s_waitcnt vmcnt(4)
    v_mov_b32 v98, s62
    v_mov_b32 v99, 0
    s_mov_b64 exec, 1
    s_cmp_eq_u32 s63, 0
    s_cbranch_scc1 FS_26
    buffer_store_dword v98, v99, s[40:43], s17 offen
    s_branch FD_27
FS_26:
    buffer_wbl2 sc1
    s_waitcnt vmcnt(0)
    buffer_store_dword v98, v99, s[40:43], s17 offen sc1
FD_27:
    s_mov_b64 exec, -1
    v_mfma_f32_16x16x32_bf16 v[80:83], v[160:163], v[32:35], v[80:83]
    v_mfma_f32_16x16x32_bf16 v[84:87], v[164:167], v[32:35], v[84:87]
    v_mfma_f32_16x16x32_bf16 v[88:91], v[168:171], v[32:35], v[88:91]
    v_mfma_f32_16x16x32_bf16 v[92:95], v[172:175], v[32:35], v[92:95]
    v_mfma_f32_16x16x32_bf16 v[80:83], v[176:179], v[36:39], v[80:83]
    v_mfma_f32_16x16x32_bf16 v[84:87], v[180:183], v[36:39], v[84:87]
    v_mfma_f32_16x16x32_bf16 v[88:91], v[184:187], v[36:39], v[88:91]
    v_mfma_f32_16x16x32_bf16 v[92:95], v[188:191], v[36:39], v[92:95]
    v_mfma_f32_16x16x32_bf16 v[64:67], v[112:115], v[40:43], 0
    v_mfma_f32_16x16x32_bf16 v[68:71], v[116:119], v[40:43], 0
    v_mfma_f32_16x16x32_bf16 v[72:75], v[120:123], v[40:43], 0
    v_mfma_f32_16x16x32_bf16 v[76:79], v[124:127], v[40:43], 0
    s_nop 0
    ds_write_b128 v2, v[80:83] offset:16384
    ds_write_b128 v2, v[84:87] offset:17408
    v_mfma_f32_16x16x32_bf16 v[64:67], v[128:131], v[44:47], v[64:67]
    v_mfma_f32_16x16x32_bf16 v[68:71], v[132:135], v[44:47], v[68:71]
    v_mfma_f32_16x16x32_bf16 v[72:75], v[136:139], v[44:47], v[72:75]
    v_mfma_f32_16x16x32_bf16 v[76:79], v[140:143], v[44:47], v[76:79]
    ds_write_b128 v2, v[88:91] offset:18432
    ds_write_b128 v2, v[92:95] offset:19456
    v_mfma_f32_16x16x32_bf16 v[64:67], v[144:147], v[48:51], v[64:67]
    v_mfma_f32_16x16x32_bf16 v[68:71], v[148:151], v[48:51], v[68:71]
    v_mfma_f32_16x16x32_bf16 v[72:75], v[152:155], v[48:51], v[72:75]
    v_mfma_f32_16x16x32_bf16 v[76:79], v[156:159], v[48:51], v[76:79]
    v_mov_b32 v98, 0
    v_mov_b32 v99, 1
    s_mov_b64 exec, 1
    ds_add_u32 v98, v99 offset:52
    s_mov_b64 exec, -1
    v_mfma_f32_16x16x32_bf16 v[64:67], v[160:163], v[52:55], v[64:67]
    v_mfma_f32_16x16x32_bf16 v[68:71], v[164:167], v[52:55], v[68:71]
    v_mfma_f32_16x16x32_bf16 v[72:75], v[168:171], v[52:55], v[72:75]
    v_mfma_f32_16x16x32_bf16 v[76:79], v[172:175], v[52:55], v[76:79]
    v_mfma_f32_16x16x32_bf16 v[64:67], v[176:179], v[56:59], v[64:67]
    v_mfma_f32_16x16x32_bf16 v[68:71], v[180:183], v[56:59], v[68:71]
    v_mfma_f32_16x16x32_bf16 v[72:75], v[184:187], v[56:59], v[72:75]
    v_mfma_f32_16x16x32_bf16 v[76:79], v[188:191], v[56:59], v[76:79]
    v_mfma_f32_16x16x32_bf16 v[80:83], v[112:115], v[60:63], 0
    v_mfma_f32_16x16x32_bf16 v[84:87], v[116:119], v[60:63], 0
    v_mfma_f32_16x16x32_bf16 v[88:91], v[120:123], v[60:63], 0
    v_mfma_f32_16x16x32_bf16 v[92:95], v[124:127], v[60:63], 0
    s_nop 0
    ds_write_b128 v2, v[64:67] offset:32768
    ds_write_b128 v2, v[68:71] offset:33792
    v_mfma_f32_16x16x32_bf16 v[80:83], v[128:131], v[16:19], v[80:83]
    v_mfma_f32_16x16x32_bf16 v[84:87], v[132:135], v[16:19], v[84:87]
    v_mfma_f32_16x16x32_bf16 v[88:91], v[136:139], v[16:19], v[88:91]
    v_mfma_f32_16x16x32_bf16 v[92:95], v[140:143], v[16:19], v[92:95]
    ds_write_b128 v2, v[72:75] offset:34816
    ds_write_b128 v2, v[76:79] offset:35840
    s_waitcnt vmcnt(4)
    v_mfma_f32_16x16x32_bf16 v[80:83], v[144:147], v[20:23], v[80:83]
    v_mfma_f32_16x16x32_bf16 v[84:87], v[148:151], v[20:23], v[84:87]
    v_mfma_f32_16x16x32_bf16 v[88:91], v[152:155], v[20:23], v[88:91]
    v_mfma_f32_16x16x32_bf16 v[92:95], v[156:159], v[20:23], v[92:95]
    v_mov_b32 v98, 0
    v_mov_b32 v99, 1
    s_mov_b64 exec, 1
    ds_add_u32 v98, v99 offset:56
    s_mov_b64 exec, -1
    s_waitcnt vmcnt(3)
    v_mfma_f32_16x16x32_bf16 v[80:83], v[160:163], v[24:27], v[80:83]
    v_mfma_f32_16x16x32_bf16 v[84:87], v[164:167], v[24:27], v[84:87]
    v_mfma_f32_16x16x32_bf16 v[88:91], v[168:171], v[24:27], v[88:91]
    v_mfma_f32_16x16x32_bf16 v[92:95], v[172:175], v[24:27], v[92:95]
    s_waitcnt vmcnt(2)
    v_mfma_f32_16x16x32_bf16 v[80:83], v[176:179], v[28:31], v[80:83]
    v_mfma_f32_16x16x32_bf16 v[84:87], v[180:183], v[28:31], v[84:87]
    v_mfma_f32_16x16x32_bf16 v[88:91], v[184:187], v[28:31], v[88:91]
    v_mfma_f32_16x16x32_bf16 v[92:95], v[188:191], v[28:31], v[92:95]
    s_nop 4
    ds_write_b128 v2, v[80:83] offset:49152
    ds_write_b128 v2, v[84:87] offset:50176
    ds_write_b128 v2, v[88:91] offset:51200
    ds_write_b128 v2, v[92:95] offset:52224
    v_mov_b32 v98, 0
    v_mov_b32 v99, 1
    s_mov_b64 exec, 1
    ds_add_u32 v98, v99 offset:60
    s_mov_b64 exec, -1
    s_mov_b32 s67, -1
    s_mov_b32 s70, 40000
    s_waitcnt vmcnt(1)
    s_branch FPC_30
FP_28:
    buffer_load_dword v7, v6, s[40:43], s10 offen sc1
    s_waitcnt vmcnt(0)
FPC_30:
    v_cmp_eq_u32 vcc, s62, v7
    s_nop 0
    s_and_b32 s71, vcc_lo, s67
    s_cmp_eq_u32 s71, s67
    s_cbranch_scc1 FPD_29
    s_sub_u32 s70, s70, 1
    s_cbranch_scc1 FPD_29
    s_sleep 1
    s_branch FP_28
FPD_29:
    v_and_b32 v6, 15, v0
    v_lshlrev_b32 v6, 4, v6
    v_bfe_u32 v7, v0, 4, 1
    v_lshl_or_b32 v6, v7, 9, v6
    v_lshrrev_b32 v7, 5, v0
    v_lshl_or_b32 v6, v7, 10, v6
    buffer_load_dwordx4 v[104:107], v6, s[40:43], s11 offen sc1
    buffer_load_dwordx4 v[108:111], v6, s[40:43], s11 offen offset:256 sc1
    buffer_load_dwordx4 v[112:115], v6, s[40:43], s11 offen offset:2048 sc1
    buffer_load_dwordx4 v[116:119], v6, s[40:43], s11 offen offset:2304 sc1
    s_branch L_FINL
L_MLP_C:
    s_lshr_b32 s16, s60, 1
    s_and_b32 s17, s60, 1
    s_lshl_b32 s64, s16, 13
    s_add_u32 s64, s64, 4096
    v_and_b32 v12, 15, v0
    v_lshlrev_b32 v1, 7, v12
    v_lshrrev_b32 v12, 1, v12
    v_lshrrev_b32 v2, 4, v0
    v_xor_b32 v12, v12, v2
    v_lshl_or_b32 v1, v12, 4, v1
    v_add_u32 v1, s64, v1
    v_xor_b32 v2, 64, v1
    v_lshrrev_b32 v13, 4, v0
    v_lshlrev_b32 v12, 10, v13
    v_and_b32 v13, 1, v13
    v_lshl_or_b32 v12, v13, 6, v12
    v_bfe_u32 v13, v0, 2, 2
    v_lshl_or_b32 v12, v13, 7, v12
    v_bfe_u32 v13, v0, 3, 1
    v_lshl_or_b32 v12, v13, 5, v12
    v_and_b32 v13, 3, v0
    v_lshl_or_b32 v12, v13, 3, v12
    v_lshrrev_b32 v13, 4, v0
    v_lshlrev_b32 v9, 9, v13
    v_and_b32 v13, 1, v13
    v_lshl_or_b32 v9, v13, 5, v9
    v_bfe_u32 v13, v0, 2, 2
    v_lshl_or_b32 v9, v13, 6, v9
    v_and_b32 v13, 3, v0
    v_lshl_or_b32 v9, v13, 3, v9
    s_lshl_b32 s64, s17, 14
    s_add_u32 s64, s64, 20480
    s_lshl_b32 s65, s17, 6
    s_add_u32 s65, s65, 28672
    v_xor_b32 v3, s64, v12
    v_xor_b32 v4, 32, v3
    v_xor_b32 v5, 64, v3
    v_xor_b32 v6, 0x60, v3
    v_xor_b32 v7, s65, v12
    v_xor_b32 v8, 32, v7
    s_lshl_b32 s64, s17, 5
    v_xor_b32 v9, s64, v9
    v_add_u32 v9, 45056, v9
    v_lshrrev_b32 v13, 4, v0
    v_lshlrev_b32 v10, 4, v13
    s_lshl_b32 s64, s17, 6
    v_add_u32 v12, s64, v10
    v_add_u32 v11, s64, v12
    s_lshl_b32 s64, s17, 9
    v_add_u32 v10, s64, v10
    v_and_b32 v13, 15, v0
    v_lshlrev_b32 v13, 2, v13
    s_and_b32 s65, s56, 1
    s_lshl_b32 s65, s65, 9
    s_lshl_b32 s64, s16, 8
    s_add_u32 s64, s64, s65
    v_add_u32 v13, s64, v13
    v_mov_b32 v232, 0
    v_mov_b32 v233, 0
    v_mov_b32 v234, 0
    v_mov_b32 v235, 0
    s_nop 1
    v_mfma_f32_32x32x16_bf16 v[16:31], v[232:235], v[232:235], 0
    v_mfma_f32_32x32x16_bf16 v[32:47], v[232:235], v[232:235], 0
    v_mfma_f32_32x32x16_bf16 v[48:63], v[232:235], v[232:235], 0
    v_mfma_f32_32x32x16_bf16 v[64:79], v[232:235], v[232:235], 0
    v_mfma_f32_32x32x16_bf16 v[80:95], v[232:235], v[232:235], 0
    v_mfma_f32_32x32x16_bf16 v[96:111], v[232:235], v[232:235], 0
    v_mfma_f32_32x32x16_bf16 v[112:127], v[232:235], v[232:235], 0
    s_and_b32 s65, s59, 1
    s_mul_i32 s64, s59, 7
    s_mul_i32 s68, s56, 576
    s_add_u32 s68, s68, s64
    s_mul_i32 s64, s16, 288
    s_add_u32 s68, s68, s64
    s_lshl_b32 s68, s68, 10
    s_lshl_b32 s64, s65, 10
    s_add_u32 s12, s68, s64
    s_lshl_b32 s64, s17, 10
    s_add_u32 s13, s12, s64
    s_add_u32 s13, s13, 2048
    s_lshl_b32 s64, s17, 12
    s_add_u32 s12, s12, s64
    s_cmp_eq_u32 s65, 0
    s_cselect_b32 s64, 6144, 0
    s_add_u32 s14, s68, s64
    s_lshl_b32 s64, s17, 3
    s_add_u32 s14, s14, s64
    s_add_u32 s15, s12, 1024
    v_lshlrev_b32 v14, 4, v0
    s_lshl_b32 s64, s56, 8
    s_lshl_b32 s65, s59, 4
    s_add_u32 s64, s64, s65
    s_lshl_b32 s65, s60, 2
    s_add_u32 s64, s64, s65
    s_add_u32 s18, s64, 9474176
    s_lshl_b32 s64, s57, 2
    s_add_u32 s64, s64, s60
    v_lshlrev_b32 v254, 10, v0
    v_add_u32 v254, 384, v254
    s_mul_i32 s65, s64, 12288
    s_mov_b64 exec, 0xfff
    buffer_load_dword v255, v254, s[28:31], s65 offen
    s_mov_b64 exec, -1
    s_call_b64 s[8:9], L_STATS
    s_barrier
    ds_read_b128 v[144:147], v1 offset:0
    ds_read_b128 v[148:151], v1 offset:2048
    ds_read_b128 v[152:155], v1 offset:4096
    ds_read_b128 v[156:159], v1 offset:6144
    ds_read_b64_tr_b16 v[176:177], v3 offset:0
    ds_read_b64_tr_b16 v[178:179], v3 offset:512
    ds_read_b64_tr_b16 v[180:181], v4 offset:0
    ds_read_b64_tr_b16 v[182:183], v4 offset:512
    ds_read_b64_tr_b16 v[184:185], v5 offset:0
    ds_read_b64_tr_b16 v[186:187], v5 offset:512
    ds_read_b64_tr_b16 v[188:189], v6 offset:0
    ds_read_b64_tr_b16 v[190:191], v6 offset:512
    ds_read_b64_tr_b16 v[192:193], v7 offset:0
    ds_read_b64_tr_b16 v[194:195], v7 offset:512
    ds_read_b64_tr_b16 v[196:197], v8 offset:0
    ds_read_b64_tr_b16 v[198:199], v8 offset:512
    ds_read_b64_tr_b16 v[200:201], v9 offset:0
    ds_read_b64_tr_b16 v[202:203], v9 offset:256
    s_mov_b32 s66, 0
    s_mov_b32 s67, 45056
    s_mov_b32 s68, 45056
    s_mov_b32 s69, 4294877184
L_MC_MID:
    s_waitcnt lgkmcnt(12)
    v_mfma_f32_16x16x32_bf16 v[16:19], v[176:179], v[144:147], v[16:19]
    ds_read_b128 v[160:163], v2 offset:0
    v_mfma_f32_16x16x32_bf16 v[20:23], v[176:179], v[148:151], v[20:23]
    ds_read_b128 v[164:167], v2 offset:2048
    v_mfma_f32_16x16x32_bf16 v[24:27], v[176:179], v[152:155], v[24:27]
    ds_read_b128 v[168:171], v2 offset:4096
    v_mfma_f32_16x16x32_bf16 v[28:31], v[176:179], v[156:159], v[28:31]
    ds_read_b128 v[172:175], v2 offset:6144
    s_waitcnt lgkmcnt(14)
    v_mfma_f32_16x16x32_bf16 v[32:35], v[180:183], v[144:147], v[32:35]
    ds_read_b64_tr_b16 v[204:205], v3 offset:4096
    v_mfma_f32_16x16x32_bf16 v[36:39], v[180:183], v[148:151], v[36:39]
    ds_read_b64_tr_b16 v[206:207], v3 offset:4608
    v_mfma_f32_16x16x32_bf16 v[40:43], v[180:183], v[152:155], v[40:43]
    ds_read_b64_tr_b16 v[208:209], v4 offset:4096
    v_mfma_f32_16x16x32_bf16 v[44:47], v[180:183], v[156:159], v[44:47]
    ds_read_b64_tr_b16 v[210:211], v4 offset:4608
    s_waitcnt lgkmcnt(14)
    v_mfma_f32_16x16x32_bf16 v[48:51], v[184:187], v[144:147], v[48:51]
    ds_read_b64_tr_b16 v[212:213], v5 offset:4096
    v_mfma_f32_16x16x32_bf16 v[52:55], v[184:187], v[148:151], v[52:55]
    ds_read_b64_tr_b16 v[214:215], v5 offset:4608
    v_mfma_f32_16x16x32_bf16 v[56:59], v[184:187], v[152:155], v[56:59]
    ds_read_b64_tr_b16 v[216:217], v6 offset:4096
    v_mfma_f32_16x16x32_bf16 v[60:63], v[184:187], v[156:159], v[60:63]
    ds_read_b64_tr_b16 v[218:219], v6 offset:4608
    v_mfma_f32_16x16x32_bf16 v[64:67], v[188:191], v[144:147], v[64:67]
    ds_read_b64_tr_b16 v[220:221], v7 offset:4096
    v_mfma_f32_16x16x32_bf16 v[68:71], v[188:191], v[148:151], v[68:71]
    ds_read_b64_tr_b16 v[222:223], v7 offset:4608
    v_mfma_f32_16x16x32_bf16 v[72:75], v[188:191], v[152:155], v[72:75]
    ds_read_b64_tr_b16 v[224:225], v8 offset:4096
    v_mfma_f32_16x16x32_bf16 v[76:79], v[188:191], v[156:159], v[76:79]
    ds_read_b64_tr_b16 v[226:227], v8 offset:4608
    s_waitcnt lgkmcnt(14)
    v_mfma_f32_16x16x32_bf16 v[80:83], v[192:195], v[144:147], v[80:83]
    ds_read_b64_tr_b16 v[228:229], v9 offset:2048
    v_mfma_f32_16x16x32_bf16 v[84:87], v[192:195], v[148:151], v[84:87]
    ds_read_b64_tr_b16 v[230:231], v9 offset:2304
    v_mfma_f32_16x16x32_bf16 v[88:91], v[192:195], v[152:155], v[88:91]
    v_add_u32 v1, s67, v1
    v_mfma_f32_16x16x32_bf16 v[92:95], v[192:195], v[156:159], v[92:95]
    v_add_u32 v2, s67, v2
    v_mfma_f32_16x16x32_bf16 v[96:99], v[196:199], v[144:147], v[96:99]
    v_add_u32 v3, s67, v3
    v_mfma_f32_16x16x32_bf16 v[100:103], v[196:199], v[148:151], v[100:103]
    s_waitcnt lgkmcnt(0)
    s_barrier
    v_mfma_f32_16x16x32_bf16 v[104:107], v[196:199], v[152:155], v[104:107]
    v_add_u32 v4, s67, v4
    v_mfma_f32_16x16x32_bf16 v[108:111], v[196:199], v[156:159], v[108:111]
    v_add_u32 v5, s67, v5
    v_mfma_f32_16x16x32_bf16 v[112:115], v[200:203], v[144:147], v[112:115]
    v_add_u32 v6, s67, v6
    v_mfma_f32_16x16x32_bf16 v[116:119], v[200:203], v[148:151], v[116:119]
    v_add_u32 v7, s67, v7
    v_mfma_f32_16x16x32_bf16 v[120:123], v[200:203], v[152:155], v[120:123]
    v_add_u32 v8, s67, v8
    v_mfma_f32_16x16x32_bf16 v[124:127], v[200:203], v[156:159], v[124:127]
    v_add_u32 v9, s67, v9
    v_mfma_f32_16x16x32_bf16 v[16:19], v[204:207], v[160:163], v[16:19]
    ds_read_b128 v[144:147], v1 offset:0
    v_mfma_f32_16x16x32_bf16 v[20:23], v[204:207], v[164:167], v[20:23]
    ds_read_b128 v[148:151], v1 offset:2048
    v_mfma_f32_16x16x32_bf16 v[24:27], v[204:207], v[168:171], v[24:27]
    ds_read_b128 v[152:155], v1 offset:4096
    v_mfma_f32_16x16x32_bf16 v[28:31], v[204:207], v[172:175], v[28:31]
    ds_read_b128 v[156:159], v1 offset:6144
    v_mfma_f32_16x16x32_bf16 v[32:35], v[208:211], v[160:163], v[32:35]
    ds_read_b64_tr_b16 v[176:177], v3 offset:0
    v_mfma_f32_16x16x32_bf16 v[36:39], v[208:211], v[164:167], v[36:39]
    ds_read_b64_tr_b16 v[178:179], v3 offset:512
    v_mfma_f32_16x16x32_bf16 v[40:43], v[208:211], v[168:171], v[40:43]
    ds_read_b64_tr_b16 v[180:181], v4 offset:0
    v_mfma_f32_16x16x32_bf16 v[44:47], v[208:211], v[172:175], v[44:47]
    ds_read_b64_tr_b16 v[182:183], v4 offset:512
    v_mfma_f32_16x16x32_bf16 v[48:51], v[212:215], v[160:163], v[48:51]
    ds_read_b64_tr_b16 v[184:185], v5 offset:0
    v_mfma_f32_16x16x32_bf16 v[52:55], v[212:215], v[164:167], v[52:55]
    ds_read_b64_tr_b16 v[186:187], v5 offset:512
    v_mfma_f32_16x16x32_bf16 v[56:59], v[212:215], v[168:171], v[56:59]
    ds_read_b64_tr_b16 v[188:189], v6 offset:0
    v_mfma_f32_16x16x32_bf16 v[60:63], v[212:215], v[172:175], v[60:63]
    ds_read_b64_tr_b16 v[190:191], v6 offset:512
    v_mfma_f32_16x16x32_bf16 v[64:67], v[216:219], v[160:163], v[64:67]
    ds_read_b64_tr_b16 v[192:193], v7 offset:0
    v_mfma_f32_16x16x32_bf16 v[68:71], v[216:219], v[164:167], v[68:71]
    ds_read_b64_tr_b16 v[194:195], v7 offset:512
    v_mfma_f32_16x16x32_bf16 v[72:75], v[216:219], v[168:171], v[72:75]
    ds_read_b64_tr_b16 v[196:197], v8 offset:0
    v_mfma_f32_16x16x32_bf16 v[76:79], v[216:219], v[172:175], v[76:79]
    ds_read_b64_tr_b16 v[198:199], v8 offset:512
    v_mfma_f32_16x16x32_bf16 v[80:83], v[220:223], v[160:163], v[80:83]
    ds_read_b64_tr_b16 v[200:201], v9 offset:0
    v_mfma_f32_16x16x32_bf16 v[84:87], v[220:223], v[164:167], v[84:87]
    ds_read_b64_tr_b16 v[202:203], v9 offset:256
    v_mfma_f32_16x16x32_bf16 v[88:91], v[220:223], v[168:171], v[88:91]
    s_mov_b32 s64, s67
    v_mfma_f32_16x16x32_bf16 v[92:95], v[220:223], v[172:175], v[92:95]
    s_mov_b32 s67, s68
    v_mfma_f32_16x16x32_bf16 v[96:99], v[224:227], v[160:163], v[96:99]
    s_mov_b32 s68, s69
    v_mfma_f32_16x16x32_bf16 v[100:103], v[224:227], v[164:167], v[100:103]
    s_mov_b32 s69, s64
    v_mfma_f32_16x16x32_bf16 v[104:107], v[224:227], v[168:171], v[104:107]
    s_add_u32 s66, s66, 1
    v_mfma_f32_16x16x32_bf16 v[108:111], v[224:227], v[172:175], v[108:111]
    s_cmp_eq_u32 s66, 6
    v_mfma_f32_16x16x32_bf16 v[112:115], v[228:231], v[160:163], v[112:115]
    v_mfma_f32_16x16x32_bf16 v[116:119], v[228:231], v[164:167], v[116:119]
    v_mfma_f32_16x16x32_bf16 v[120:123], v[228:231], v[168:171], v[120:123]
    v_mfma_f32_16x16x32_bf16 v[124:127], v[228:231], v[172:175], v[124:127]
    s_cbranch_scc0 L_MC_MID
    s_waitcnt lgkmcnt(12)
    v_mfma_f32_16x16x32_bf16 v[16:19], v[176:179], v[144:147], v[16:19]
    ds_read_b128 v[160:163], v2 offset:0
    v_mfma_f32_16x16x32_bf16 v[20:23], v[176:179], v[148:151], v[20:23]
    ds_read_b128 v[164:167], v2 offset:2048
    v_mfma_f32_16x16x32_bf16 v[24:27], v[176:179], v[152:155], v[24:27]
    ds_read_b128 v[168:171], v2 offset:4096
    v_mfma_f32_16x16x32_bf16 v[28:31], v[176:179], v[156:159], v[28:31]
    ds_read_b128 v[172:175], v2 offset:6144
    s_waitcnt lgkmcnt(14)
    v_mfma_f32_16x16x32_bf16 v[32:35], v[180:183], v[144:147], v[32:35]
    ds_read_b64_tr_b16 v[204:205], v3 offset:4096
    v_mfma_f32_16x16x32_bf16 v[36:39], v[180:183], v[148:151], v[36:39]
    ds_read_b64_tr_b16 v[206:207], v3 offset:4608
    v_mfma_f32_16x16x32_bf16 v[40:43], v[180:183], v[152:155], v[40:43]
    ds_read_b64_tr_b16 v[208:209], v4 offset:4096
    v_mfma_f32_16x16x32_bf16 v[44:47], v[180:183], v[156:159], v[44:47]
    ds_read_b64_tr_b16 v[210:211], v4 offset:4608
    s_waitcnt lgkmcnt(14)
    v_mfma_f32_16x16x32_bf16 v[48:51], v[184:187], v[144:147], v[48:51]
    ds_read_b64_tr_b16 v[212:213], v5 offset:4096
    v_mfma_f32_16x16x32_bf16 v[52:55], v[184:187], v[148:151], v[52:55]
    ds_read_b64_tr_b16 v[214:215], v5 offset:4608
    v_mfma_f32_16x16x32_bf16 v[56:59], v[184:187], v[152:155], v[56:59]
    ds_read_b64_tr_b16 v[216:217], v6 offset:4096
    v_mfma_f32_16x16x32_bf16 v[60:63], v[184:187], v[156:159], v[60:63]
    ds_read_b64_tr_b16 v[218:219], v6 offset:4608
    v_mfma_f32_16x16x32_bf16 v[64:67], v[188:191], v[144:147], v[64:67]
    ds_read_b64_tr_b16 v[220:221], v7 offset:4096
    v_mfma_f32_16x16x32_bf16 v[68:71], v[188:191], v[148:151], v[68:71]
    ds_read_b64_tr_b16 v[222:223], v7 offset:4608
    v_mfma_f32_16x16x32_bf16 v[72:75], v[188:191], v[152:155], v[72:75]
    ds_read_b64_tr_b16 v[224:225], v8 offset:4096
    v_mfma_f32_16x16x32_bf16 v[76:79], v[188:191], v[156:159], v[76:79]
    ds_read_b64_tr_b16 v[226:227], v8 offset:4608
    s_waitcnt lgkmcnt(14)
    v_mfma_f32_16x16x32_bf16 v[80:83], v[192:195], v[144:147], v[80:83]
    ds_read_b64_tr_b16 v[228:229], v9 offset:2048
    v_mfma_f32_16x16x32_bf16 v[84:87], v[192:195], v[148:151], v[84:87]
    ds_read_b64_tr_b16 v[230:231], v9 offset:2304
    v_mfma_f32_16x16x32_bf16 v[88:91], v[192:195], v[152:155], v[88:91]
    v_add_u32 v1, s67, v1
    v_mfma_f32_16x16x32_bf16 v[92:95], v[192:195], v[156:159], v[92:95]
    v_add_u32 v2, s67, v2
    v_mfma_f32_16x16x32_bf16 v[96:99], v[196:199], v[144:147], v[96:99]
    v_add_u32 v3, s67, v3
    v_mfma_f32_16x16x32_bf16 v[100:103], v[196:199], v[148:151], v[100:103]
    s_waitcnt lgkmcnt(0)
    s_barrier
    ds_read_b32 v244, v13 offset:1024
    ds_read_b32 v245, v13 offset:1088
    v_mfma_f32_16x16x32_bf16 v[104:107], v[196:199], v[152:155], v[104:107]
    v_add_u32 v4, s67, v4
    ds_read_b32 v246, v13 offset:1152
    ds_read_b32 v247, v13 offset:1216
    v_mfma_f32_16x16x32_bf16 v[108:111], v[196:199], v[156:159], v[108:111]
    v_add_u32 v5, s67, v5
    ds_read_b128 v[128:131], v10 offset:3072
    ds_read_b128 v[132:135], v10 offset:3136
    v_mfma_f32_16x16x32_bf16 v[112:115], v[200:203], v[144:147], v[112:115]
    v_add_u32 v6, s67, v6
    ds_read_b128 v[136:139], v10 offset:3200
    ds_read_b128 v[140:143], v10 offset:3264
    v_mfma_f32_16x16x32_bf16 v[116:119], v[200:203], v[148:151], v[116:119]
    v_add_u32 v7, s67, v7
    ds_read_b128 v[232:235], v11 offset:3328
    ds_read_b128 v[236:239], v11 offset:3392
    v_mfma_f32_16x16x32_bf16 v[120:123], v[200:203], v[152:155], v[120:123]
    v_add_u32 v8, s67, v8
    ds_read_b128 v[240:243], v12 offset:3840
    v_mfma_f32_16x16x32_bf16 v[124:127], v[200:203], v[156:159], v[124:127]
    v_add_u32 v9, s67, v9
    s_setprio 3
    v_mfma_f32_16x16x32_bf16 v[16:19], v[204:207], v[160:163], v[16:19]
    ds_read_b128 v[144:147], v1 offset:0
    v_mfma_f32_16x16x32_bf16 v[20:23], v[204:207], v[164:167], v[20:23]
    ds_read_b128 v[148:151], v1 offset:2048
    v_mfma_f32_16x16x32_bf16 v[24:27], v[204:207], v[168:171], v[24:27]
    ds_read_b128 v[152:155], v1 offset:4096
    v_mfma_f32_16x16x32_bf16 v[28:31], v[204:207], v[172:175], v[28:31]
    ds_read_b128 v[156:159], v1 offset:6144
    s_waitcnt lgkmcnt(9)
    v_fmac_f32 v40, v132, v246
    v_fmac_f32 v41, v133, v246
    v_mfma_f32_16x16x32_bf16 v[32:35], v[208:211], v[160:163], v[32:35]
    ds_read_b64_tr_b16 v[176:177], v3 offset:0
    v_fmac_f32 v44, v132, v247
    v_fmac_f32 v45, v133, v247
    v_mfma_f32_16x16x32_bf16 v[36:39], v[208:211], v[164:167], v[36:39]
    ds_read_b64_tr_b16 v[178:179], v3 offset:512
    v_fmac_f32 v16, v128, v244
    v_fmac_f32 v17, v129, v244
    v_mfma_f32_16x16x32_bf16 v[40:43], v[208:211], v[168:171], v[40:43]
    ds_read_b64_tr_b16 v[180:181], v4 offset:0
    v_fmac_f32 v20, v128, v245
    v_fmac_f32 v21, v129, v245
    v_mfma_f32_16x16x32_bf16 v[44:47], v[208:211], v[172:175], v[44:47]
    ds_read_b64_tr_b16 v[182:183], v4 offset:512
    v_fmac_f32 v24, v128, v246
    v_fmac_f32 v25, v129, v246
    v_mfma_f32_16x16x32_bf16 v[48:51], v[212:215], v[160:163], v[48:51]
    ds_read_b64_tr_b16 v[184:185], v5 offset:0
    v_fmac_f32 v28, v128, v247
    v_fmac_f32 v29, v129, v247
    v_mfma_f32_16x16x32_bf16 v[52:55], v[212:215], v[164:167], v[52:55]
    ds_read_b64_tr_b16 v[186:187], v5 offset:512
    v_fmac_f32 v32, v132, v244
    v_fmac_f32 v33, v133, v244
    v_mfma_f32_16x16x32_bf16 v[56:59], v[212:215], v[168:171], v[56:59]
    ds_read_b64_tr_b16 v[188:189], v6 offset:0
    v_fmac_f32 v36, v132, v245
    v_fmac_f32 v37, v133, v245
    v_mfma_f32_16x16x32_bf16 v[60:63], v[212:215], v[172:175], v[60:63]
    ds_read_b64_tr_b16 v[190:191], v6 offset:512
    s_waitcnt lgkmcnt(14)
    v_fmac_f32 v72, v140, v246
    v_fmac_f32 v73, v141, v246
    v_mfma_f32_16x16x32_bf16 v[64:67], v[216:219], v[160:163], v[64:67]
    ds_read_b64_tr_b16 v[192:193], v7 offset:0
    v_fmac_f32 v76, v140, v247
    v_fmac_f32 v77, v141, v247
    v_mfma_f32_16x16x32_bf16 v[68:71], v[216:219], v[164:167], v[68:71]
    ds_read_b64_tr_b16 v[194:195], v7 offset:512
    v_fmac_f32 v48, v136, v244
    v_fmac_f32 v49, v137, v244
    v_mfma_f32_16x16x32_bf16 v[72:75], v[216:219], v[168:171], v[72:75]
    ds_read_b64_tr_b16 v[196:197], v8 offset:0
    v_fmac_f32 v52, v136, v245
    v_fmac_f32 v53, v137, v245
    v_mfma_f32_16x16x32_bf16 v[76:79], v[216:219], v[172:175], v[76:79]
    ds_read_b64_tr_b16 v[198:199], v8 offset:512
    v_fmac_f32 v56, v136, v246
    v_fmac_f32 v57, v137, v246
    v_mfma_f32_16x16x32_bf16 v[80:83], v[220:223], v[160:163], v[80:83]
    ds_read_b64_tr_b16 v[200:201], v9 offset:0
    v_fmac_f32 v60, v136, v247
    v_fmac_f32 v61, v137, v247
    v_mfma_f32_16x16x32_bf16 v[84:87], v[220:223], v[164:167], v[84:87]
    ds_read_b64_tr_b16 v[202:203], v9 offset:256
    v_fmac_f32 v64, v140, v244
    v_fmac_f32 v65, v141, v244
    v_mfma_f32_16x16x32_bf16 v[88:91], v[220:223], v[168:171], v[88:91]
    v_fmac_f32 v68, v140, v245
    v_fmac_f32 v69, v141, v245
    v_fmac_f32 v70, v142, v245
    v_mfma_f32_16x16x32_bf16 v[92:95], v[220:223], v[172:175], v[92:95]
    s_waitcnt lgkmcnt(14)
    v_fmac_f32 v104, v236, v246
    v_fmac_f32 v105, v237, v246
    v_fmac_f32 v106, v238, v246
    v_mfma_f32_16x16x32_bf16 v[96:99], v[224:227], v[160:163], v[96:99]
    v_fmac_f32 v108, v236, v247
    v_fmac_f32 v109, v237, v247
    v_fmac_f32 v110, v238, v247
    v_mfma_f32_16x16x32_bf16 v[100:103], v[224:227], v[164:167], v[100:103]
    v_fmac_f32 v80, v232, v244
    v_fmac_f32 v81, v233, v244
    v_fmac_f32 v82, v234, v244
    v_mfma_f32_16x16x32_bf16 v[104:107], v[224:227], v[168:171], v[104:107]
    v_fmac_f32 v84, v232, v245
    v_fmac_f32 v85, v233, v245
    v_fmac_f32 v86, v234, v245
    v_mfma_f32_16x16x32_bf16 v[108:111], v[224:227], v[172:175], v[108:111]
    v_fmac_f32 v88, v232, v246
    v_fmac_f32 v89, v233, v246
    v_fmac_f32 v90, v234, v246
    v_mfma_f32_16x16x32_bf16 v[112:115], v[228:231], v[160:163], v[112:115]
    v_fmac_f32 v92, v232, v247
    v_fmac_f32 v93, v233, v247
    v_fmac_f32 v94, v234, v247
    v_mfma_f32_16x16x32_bf16 v[116:119], v[228:231], v[164:167], v[116:119]
    v_fmac_f32 v96, v236, v244
    v_fmac_f32 v97, v237, v244
    v_fmac_f32 v98, v238, v244
    v_mfma_f32_16x16x32_bf16 v[120:123], v[228:231], v[168:171], v[120:123]
    v_fmac_f32 v100, v236, v245
    v_fmac_f32 v101, v237, v245
    v_fmac_f32 v102, v238, v245
    v_mfma_f32_16x16x32_bf16 v[124:127], v[228:231], v[172:175], v[124:127]
    v_fmac_f32 v26, v130, v246
    v_fmac_f32 v27, v131, v246
    v_fmac_f32 v30, v130, v247
    s_waitcnt lgkmcnt(12)
    v_mfma_f32_16x16x32_bf16 v[16:19], v[176:179], v[144:147], v[16:19]
    ds_read_b128 v[160:163], v2 offset:0
    v_fmac_f32 v34, v134, v244
    v_fmac_f32 v35, v135, v244
    v_mfma_f32_16x16x32_bf16 v[20:23], v[176:179], v[148:151], v[20:23]
    ds_read_b128 v[164:167], v2 offset:2048
    v_fmac_f32 v112, v240, v244
    v_fmac_f32 v113, v241, v244
    v_mfma_f32_16x16x32_bf16 v[24:27], v[176:179], v[152:155], v[24:27]
    ds_read_b128 v[168:171], v2 offset:4096
    v_fmac_f32 v116, v240, v245
    v_fmac_f32 v117, v241, v245
    v_mfma_f32_16x16x32_bf16 v[28:31], v[176:179], v[156:159], v[28:31]
    ds_read_b128 v[172:175], v2 offset:6144
    v_fmac_f32 v120, v240, v246
    v_fmac_f32 v121, v241, v246
    s_waitcnt lgkmcnt(14)
    v_mfma_f32_16x16x32_bf16 v[32:35], v[180:183], v[144:147], v[32:35]
    ds_read_b64_tr_b16 v[204:205], v3 offset:4096
    v_fmac_f32 v124, v240, v247
    v_fmac_f32 v125, v241, v247
    v_mfma_f32_16x16x32_bf16 v[36:39], v[180:183], v[148:151], v[36:39]
    ds_read_b64_tr_b16 v[206:207], v3 offset:4608
    v_fmac_f32 v18, v130, v244
    v_fmac_f32 v19, v131, v244
    v_mfma_f32_16x16x32_bf16 v[40:43], v[180:183], v[152:155], v[40:43]
    ds_read_b64_tr_b16 v[208:209], v4 offset:4096
    v_fmac_f32 v22, v130, v245
    v_fmac_f32 v23, v131, v245
    v_mfma_f32_16x16x32_bf16 v[44:47], v[180:183], v[156:159], v[44:47]
    ds_read_b64_tr_b16 v[210:211], v4 offset:4608
    v_fmac_f32 v58, v138, v246
    v_fmac_f32 v59, v139, v246
    s_waitcnt lgkmcnt(14)
    v_mfma_f32_16x16x32_bf16 v[48:51], v[184:187], v[144:147], v[48:51]
    ds_read_b64_tr_b16 v[212:213], v5 offset:4096
    v_fmac_f32 v62, v138, v247
    v_fmac_f32 v63, v139, v247
    v_mfma_f32_16x16x32_bf16 v[52:55], v[184:187], v[148:151], v[52:55]
    ds_read_b64_tr_b16 v[214:215], v5 offset:4608
    v_fmac_f32 v66, v142, v244
    v_fmac_f32 v67, v143, v244
    v_mfma_f32_16x16x32_bf16 v[56:59], v[184:187], v[152:155], v[56:59]
    ds_read_b64_tr_b16 v[216:217], v6 offset:4096
    v_fmac_f32 v38, v134, v245
    v_fmac_f32 v39, v135, v245
    v_mfma_f32_16x16x32_bf16 v[60:63], v[184:187], v[156:159], v[60:63]
    ds_read_b64_tr_b16 v[218:219], v6 offset:4608
    v_fmac_f32 v42, v134, v246
    v_fmac_f32 v43, v135, v246
    v_mfma_f32_16x16x32_bf16 v[64:67], v[188:191], v[144:147], v[64:67]
    ds_read_b64_tr_b16 v[220:221], v7 offset:4096
    v_fmac_f32 v46, v134, v247
    v_fmac_f32 v47, v135, v247
    v_mfma_f32_16x16x32_bf16 v[68:71], v[188:191], v[148:151], v[68:71]
    ds_read_b64_tr_b16 v[222:223], v7 offset:4608
    v_fmac_f32 v50, v138, v244
    v_fmac_f32 v51, v139, v244
    v_mfma_f32_16x16x32_bf16 v[72:75], v[188:191], v[152:155], v[72:75]
    ds_read_b64_tr_b16 v[224:225], v8 offset:4096
    v_fmac_f32 v54, v138, v245
    v_fmac_f32 v55, v139, v245
    v_mfma_f32_16x16x32_bf16 v[76:79], v[188:191], v[156:159], v[76:79]
    ds_read_b64_tr_b16 v[226:227], v8 offset:4608
    v_fmac_f32 v114, v242, v244
    v_fmac_f32 v115, v243, v244
    s_waitcnt lgkmcnt(14)
    v_mfma_f32_16x16x32_bf16 v[80:83], v[192:195], v[144:147], v[80:83]
    ds_read_b64_tr_b16 v[228:229], v9 offset:2048
    v_fmac_f32 v118, v242, v245
    v_fmac_f32 v119, v243, v245
    v_mfma_f32_16x16x32_bf16 v[84:87], v[192:195], v[148:151], v[84:87]
    ds_read_b64_tr_b16 v[230:231], v9 offset:2304
    v_fmac_f32 v122, v242, v246
    v_fmac_f32 v123, v243, v246
    v_mfma_f32_16x16x32_bf16 v[88:91], v[192:195], v[152:155], v[88:91]
    v_mov_b32 v248, 0
    ds_read_b64 v[248:249], v248 offset:0
    v_fmac_f32 v126, v242, v247
    v_fmac_f32 v127, v243, v247
    v_mfma_f32_16x16x32_bf16 v[92:95], v[192:195], v[156:159], v[92:95]
    v_fmac_f32 v74, v142, v246
    v_fmac_f32 v75, v143, v246
    v_fmac_f32 v31, v131, v247
    v_mfma_f32_16x16x32_bf16 v[96:99], v[196:199], v[144:147], v[96:99]
    v_fmac_f32 v78, v142, v247
    v_fmac_f32 v79, v143, v247
    v_fmac_f32 v71, v143, v245
    v_mfma_f32_16x16x32_bf16 v[100:103], v[196:199], v[148:151], v[100:103]
    v_fmac_f32 v83, v235, v244
    v_mfma_f32_16x16x32_bf16 v[104:107], v[196:199], v[152:155], v[104:107]
    v_fmac_f32 v87, v235, v245
    v_mfma_f32_16x16x32_bf16 v[108:111], v[196:199], v[156:159], v[108:111]
    v_fmac_f32 v91, v235, v246
    v_mfma_f32_16x16x32_bf16 v[112:115], v[200:203], v[144:147], v[112:115]
    v_fmac_f32 v95, v235, v247
    v_mfma_f32_16x16x32_bf16 v[116:119], v[200:203], v[148:151], v[116:119]
    v_fmac_f32 v99, v239, v244
    v_mfma_f32_16x16x32_bf16 v[120:123], v[200:203], v[152:155], v[120:123]
    v_mov_b32 v10, 0
    v_mov_b32 v11, 1
    s_waitcnt lgkmcnt(0)
    s_mov_b64 exec, 1
    ds_add_u32 v10, v11 offset:8
    s_mov_b64 exec, -1
    v_fmac_f32 v103, v239, v245
    v_mfma_f32_16x16x32_bf16 v[124:127], v[200:203], v[156:159], v[124:127]
    v_fmac_f32 v107, v239, v246
    v_fmac_f32 v111, v239, v247
    s_lshl_b32 s64, s16, 13
    s_lshl_b32 s65, s17, 3
    s_add_u32 s64, s64, s65
    s_add_u32 s64, s64, 4096
    v_add_u32 v15, s64, v14
    v_mfma_f32_16x16x32_bf16 v[112:115], v[228:231], v[160:163], v[112:115]
    v_mfma_f32_16x16x32_bf16 v[116:119], v[228:231], v[164:167], v[116:119]
    v_mfma_f32_16x16x32_bf16 v[120:123], v[228:231], v[168:171], v[120:123]
    v_mfma_f32_16x16x32_bf16 v[124:127], v[228:231], v[172:175], v[124:127]
    s_nop 4
    v_cvt_pk_bf16_f32 v144, v112, v113
    v_cvt_pk_bf16_f32 v145, v114, v115
    v_pk_max_i16 v144, v144, 0
    v_pk_max_i16 v145, v145, 0
    ds_write_b64 v15, v[144:145] offset:0
    v_mfma_f32_16x16x32_bf16 v[16:19], v[204:207], v[160:163], v[16:19]
    v_cvt_pk_bf16_f32 v148, v116, v117
    v_cvt_pk_bf16_f32 v149, v118, v119
    v_pk_max_i16 v148, v148, 0
    v_pk_max_i16 v149, v149, 0
    ds_write_b64 v15, v[148:149] offset:4096
    v_mfma_f32_16x16x32_bf16 v[32:35], v[208:211], v[160:163], v[32:35]
    v_cvt_pk_bf16_f32 v152, v120, v121
    v_cvt_pk_bf16_f32 v153, v122, v123
    v_pk_max_i16 v152, v152, 0
    v_pk_max_i16 v153, v153, 0
    ds_write_b64 v15, v[152:153] offset:1024
    v_mfma_f32_16x16x32_bf16 v[20:23], v[204:207], v[164:167], v[20:23]
    v_cvt_pk_bf16_f32 v156, v124, v125
    v_cvt_pk_bf16_f32 v157, v126, v127
    v_pk_max_i16 v156, v156, 0
    v_pk_max_i16 v157, v157, 0
    ds_write_b64 v15, v[156:157] offset:5120
    v_mfma_f32_16x16x32_bf16 v[36:39], v[208:211], v[164:167], v[36:39]
    s_waitcnt lgkmcnt(0)
    s_lshl_b32 s65, s16, 2
    v_mov_b32 v10, s65
    v_mov_b32 v11, 1
    s_mov_b64 exec, 1
    ds_add_u32 v10, v11 offset:24
    s_mov_b64 exec, -1
    v_cvt_pk_bf16_f32 v176, v16, v17
    v_cvt_pk_bf16_f32 v177, v18, v19
    v_mfma_f32_16x16x32_bf16 v[24:27], v[204:207], v[168:171], v[24:27]
    v_cvt_pk_bf16_f32 v178, v32, v33
    v_cvt_pk_bf16_f32 v179, v34, v35
    v_pk_max_i16 v176, v176, 0
    v_pk_max_i16 v177, v177, 0
    v_pk_max_i16 v178, v178, 0
    v_mfma_f32_16x16x32_bf16 v[40:43], v[208:211], v[168:171], v[40:43]
    v_pk_max_i16 v179, v179, 0
    s_add_u32 s64, s12, 0
    buffer_store_dwordx4 v[176:179], v14, s[40:43], s64 offen sc1
    v_cvt_pk_bf16_f32 v180, v20, v21
    v_cvt_pk_bf16_f32 v181, v22, v23
    v_mfma_f32_16x16x32_bf16 v[28:31], v[204:207], v[172:175], v[28:31]
    v_cvt_pk_bf16_f32 v182, v36, v37
    v_cvt_pk_bf16_f32 v183, v38, v39
    v_pk_max_i16 v180, v180, 0
    v_pk_max_i16 v181, v181, 0
    v_pk_max_i16 v182, v182, 0
    v_mfma_f32_16x16x32_bf16 v[44:47], v[208:211], v[172:175], v[44:47]
    v_pk_max_i16 v183, v183, 0
    s_add_u32 s64, s12, 73728
    buffer_store_dwordx4 v[180:183], v14, s[40:43], s64 offen sc1
    v_cvt_pk_bf16_f32 v184, v24, v25
    v_cvt_pk_bf16_f32 v185, v26, v27
    v_mfma_f32_16x16x32_bf16 v[48:51], v[212:215], v[160:163], v[48:51]
    v_cvt_pk_bf16_f32 v186, v40, v41
    v_cvt_pk_bf16_f32 v187, v42, v43
    v_pk_max_i16 v184, v184, 0
    v_pk_max_i16 v185, v185, 0
    v_pk_max_i16 v186, v186, 0
    v_mfma_f32_16x16x32_bf16 v[64:67], v[216:219], v[160:163], v[64:67]
    v_pk_max_i16 v187, v187, 0
    s_add_u32 s64, s12, 147456
    buffer_store_dwordx4 v[184:187], v14, s[40:43], s64 offen sc1
    v_cvt_pk_bf16_f32 v188, v28, v29
    v_cvt_pk_bf16_f32 v189, v30, v31
    v_mfma_f32_16x16x32_bf16 v[52:55], v[212:215], v[164:167], v[52:55]
    v_cvt_pk_bf16_f32 v190, v44, v45
    v_cvt_pk_bf16_f32 v191, v46, v47
    v_pk_max_i16 v188, v188, 0
    v_pk_max_i16 v189, v189, 0
    v_pk_max_i16 v190, v190, 0
    v_mfma_f32_16x16x32_bf16 v[68:71], v[216:219], v[164:167], v[68:71]
    v_pk_max_i16 v191, v191, 0
    s_add_u32 s64, s12, 221184
    buffer_store_dwordx4 v[188:191], v14, s[40:43], s64 offen sc1
    v_cvt_pk_bf16_f32 v192, v48, v49
    v_cvt_pk_bf16_f32 v193, v50, v51
    v_mfma_f32_16x16x32_bf16 v[56:59], v[212:215], v[168:171], v[56:59]
    v_cvt_pk_bf16_f32 v194, v64, v65
    v_cvt_pk_bf16_f32 v195, v66, v67
    v_pk_max_i16 v192, v192, 0
    v_pk_max_i16 v193, v193, 0
    v_pk_max_i16 v194, v194, 0
    v_mfma_f32_16x16x32_bf16 v[72:75], v[216:219], v[168:171], v[72:75]
    v_pk_max_i16 v195, v195, 0
    s_add_u32 s64, s15, 0
    buffer_store_dwordx4 v[192:195], v14, s[40:43], s64 offen sc1
    v_cvt_pk_bf16_f32 v196, v52, v53
    v_cvt_pk_bf16_f32 v197, v54, v55
    v_mfma_f32_16x16x32_bf16 v[60:63], v[212:215], v[172:175], v[60:63]
    v_cvt_pk_bf16_f32 v198, v68, v69
    v_cvt_pk_bf16_f32 v199, v70, v71
    v_pk_max_i16 v196, v196, 0
    v_pk_max_i16 v197, v197, 0
    v_pk_max_i16 v198, v198, 0
    v_mfma_f32_16x16x32_bf16 v[76:79], v[216:219], v[172:175], v[76:79]
    v_pk_max_i16 v199, v199, 0
    s_add_u32 s64, s15, 73728
    buffer_store_dwordx4 v[196:199], v14, s[40:43], s64 offen sc1
    v_cvt_pk_bf16_f32 v200, v56, v57
    v_cvt_pk_bf16_f32 v201, v58, v59
    v_mfma_f32_16x16x32_bf16 v[80:83], v[220:223], v[160:163], v[80:83]
    v_cvt_pk_bf16_f32 v202, v72, v73
    v_cvt_pk_bf16_f32 v203, v74, v75
    v_pk_max_i16 v200, v200, 0
    v_pk_max_i16 v201, v201, 0
    v_pk_max_i16 v202, v202, 0
    v_mfma_f32_16x16x32_bf16 v[96:99], v[224:227], v[160:163], v[96:99]
    v_pk_max_i16 v203, v203, 0
    s_add_u32 s64, s15, 147456
    buffer_store_dwordx4 v[200:203], v14, s[40:43], s64 offen sc1
    v_cvt_pk_bf16_f32 v144, v60, v61
    v_cvt_pk_bf16_f32 v145, v62, v63
    v_mfma_f32_16x16x32_bf16 v[84:87], v[220:223], v[164:167], v[84:87]
    v_cvt_pk_bf16_f32 v146, v76, v77
    v_cvt_pk_bf16_f32 v147, v78, v79
    v_pk_max_i16 v144, v144, 0
    v_pk_max_i16 v145, v145, 0
    v_pk_max_i16 v146, v146, 0
    v_mfma_f32_16x16x32_bf16 v[100:103], v[224:227], v[164:167], v[100:103]
    v_pk_max_i16 v147, v147, 0
    s_add_u32 s64, s15, 221184
    buffer_store_dwordx4 v[144:147], v14, s[40:43], s64 offen sc1
    v_cvt_pk_bf16_f32 v148, v80, v81
    v_cvt_pk_bf16_f32 v149, v82, v83
    v_mfma_f32_16x16x32_bf16 v[88:91], v[220:223], v[168:171], v[88:91]
    v_cvt_pk_bf16_f32 v150, v96, v97
    v_cvt_pk_bf16_f32 v151, v98, v99
    v_pk_max_i16 v148, v148, 0
    v_pk_max_i16 v149, v149, 0
    v_pk_max_i16 v150, v150, 0
    v_mfma_f32_16x16x32_bf16 v[104:107], v[224:227], v[168:171], v[104:107]
    v_pk_max_i16 v151, v151, 0
    s_add_u32 s64, s13, 0
    buffer_store_dwordx4 v[148:151], v14, s[40:43], s64 offen sc1
    v_cvt_pk_bf16_f32 v152, v84, v85
    v_cvt_pk_bf16_f32 v153, v86, v87
    v_mfma_f32_16x16x32_bf16 v[92:95], v[220:223], v[172:175], v[92:95]
    v_cvt_pk_bf16_f32 v154, v100, v101
    v_cvt_pk_bf16_f32 v155, v102, v103
    v_pk_max_i16 v152, v152, 0
    v_pk_max_i16 v153, v153, 0
    v_pk_max_i16 v154, v154, 0
    v_mfma_f32_16x16x32_bf16 v[108:111], v[224:227], v[172:175], v[108:111]
    v_pk_max_i16 v155, v155, 0
    s_add_u32 s64, s13, 73728
    buffer_store_dwordx4 v[152:155], v14, s[40:43], s64 offen sc1
    v_cvt_pk_bf16_f32 v156, v88, v89
    v_cvt_pk_bf16_f32 v157, v90, v91
    v_cvt_pk_bf16_f32 v158, v104, v105
    v_cvt_pk_bf16_f32 v159, v106, v107
    v_pk_max_i16 v156, v156, 0
    v_pk_max_i16 v157, v157, 0
    v_pk_max_i16 v158, v158, 0
    v_pk_max_i16 v159, v159, 0
    s_lshl_b32 s65, s16, 2
    s_mov_b32 s70, 40000
    v_mov_b32 v10, s65
CW_31:
    ds_read_b32 v11, v10 offset:24
    s_waitcnt lgkmcnt(0)
    v_readfirstlane_b32 s71, v11
    s_nop 0
    s_cmp_ge_u32 s71, 2
    s_cbranch_scc1 CWD_32
    s_sub_u32 s70, s70, 1
    s_cbranch_scc1 CWD_32
    s_sleep 1
    s_branch CW_31
CWD_32:
    s_lshl_b32 s64, s60, 12
    s_add_u32 s64, s64, 4096
    v_add_u32 v15, s64, v14
    ds_read_b128 v[232:235], v15 offset:0
    ds_read_b128 v[236:239], v15 offset:1024
    s_add_u32 s64, s13, 147456
    buffer_store_dwordx4 v[156:159], v14, s[40:43], s64 offen sc1
    v_cvt_pk_bf16_f32 v176, v92, v93
    v_cvt_pk_bf16_f32 v177, v94, v95
    v_cvt_pk_bf16_f32 v178, v108, v109
    v_cvt_pk_bf16_f32 v179, v110, v111
    v_pk_max_i16 v176, v176, 0
    v_pk_max_i16 v177, v177, 0
    v_pk_max_i16 v178, v178, 0
    v_pk_max_i16 v179, v179, 0
    s_add_u32 s64, s13, 221184
    buffer_store_dwordx4 v[176:179], v14, s[40:43], s64 offen sc1
    s_mul_i32 s64, s17, 73720
    s_add_u32 s14, s14, s64
    s_waitcnt lgkmcnt(1)
    s_add_u32 s64, s14, 0
    buffer_store_dwordx4 v[232:235], v14, s[40:43], s64 offen sc1
    s_waitcnt lgkmcnt(0)
    s_add_u32 s64, s14, 147456
    buffer_store_dwordx4 v[236:239], v14, s[40:43], s64 offen sc1
    s_setprio 0
    v_readfirstlane_b32 s62, v248
    v_readfirstlane_b32 s63, v249
    s_lshl_b32 s21, s60, 12
    s_add_u32 s21, s21, 4096
    v_lshrrev_b32 v12, 3, v0
    v_lshlrev_b32 v8, 10, v12
    v_and_b32 v12, 7, v0
    v_lshrrev_b32 v13, 4, v0
    v_lshlrev_b32 v13, 1, v13
    v_xor_b32 v12, v12, v13
    v_lshl_or_b32 v8, v12, 4, v8
    s_lshl_b32 s64, s59, 7
    v_add_u32 v8, s64, v8
    v_add_u32 v9, 7168, v8
    v_add_u32 v10, 14336, v8
    v_add_u32 v11, 21504, v8
    v_lshrrev_b32 v13, 2, v0
    v_lshlrev_b32 v12, 7, v13
    v_bfe_u32 v13, v0, 3, 2
    v_lshl_or_b32 v12, v13, 5, v12
    v_and_b32 v13, 3, v0
    v_lshl_or_b32 v12, v13, 3, v12
    v_add_u32 v12, s21, v12
    v_xor_b32 v13, 32, v12
    v_xor_b32 v14, 64, v12
    v_xor_b32 v15, 96, v12
    s_lshl_b32 s23, s60, 2
    v_lshlrev_b32 v3, 2, v0
    s_lshr_b32 s69, s58, 1
    s_lshl_b32 s69, s69, 8
    s_add_u32 s69, s69, 0x909000
    s_waitcnt vmcnt(0)
    v_mov_b32 v1, s62
    v_mov_b32 v2, 0
    s_mov_b64 exec, 1
    s_cmp_eq_u32 s63, 0
    s_cbranch_scc1 FS_33
    buffer_store_dword v1, v2, s[40:43], s18 offen
    s_branch FD_34
FS_33:
    buffer_wbl2 sc1
    s_waitcnt vmcnt(0)
    buffer_store_dword v1, v2, s[40:43], s18 offen sc1
FD_34:
    s_mov_b64 exec, -1
    s_mov_b32 s70, 40000
    v_mov_b32 v6, 0
CW_35:
    ds_read_b32 v7, v6 offset:8
    s_waitcnt lgkmcnt(0)
    v_readfirstlane_b32 s71, v7
    s_nop 0
    s_cmp_ge_u32 s71, 4
    s_cbranch_scc1 CWD_36
    s_sub_u32 s70, s70, 1
    s_cbranch_scc1 CWD_36
    s_sleep 1
    s_branch CW_35
CWD_36:
    s_add_u32 m0, s21, 0x0
    s_add_u32 s64, s23, 0
    s_lshl_b32 s64, s64, 15
    buffer_load_dwordx4 v8, s[36:39], s64 offen offset:0 lds
    buffer_load_dwordx4 v9, s[36:39], s64 offen offset:1024 lds
    buffer_load_dwordx4 v10, s[36:39], s64 offen offset:2048 lds
    buffer_load_dwordx4 v11, s[36:39], s64 offen offset:3072 lds
    s_add_u32 m0, s21, 0x4000
    s_add_u32 s64, s23, 1
    s_lshl_b32 s64, s64, 15
    buffer_load_dwordx4 v8, s[36:39], s64 offen offset:0 lds
    buffer_load_dwordx4 v9, s[36:39], s64 offen offset:1024 lds
    buffer_load_dwordx4 v10, s[36:39], s64 offen offset:2048 lds
    buffer_load_dwordx4 v11, s[36:39], s64 offen offset:3072 lds
    s_add_u32 m0, s21, 0x8000
    s_add_u32 s64, s23, 2
    s_lshl_b32 s64, s64, 15
    buffer_load_dwordx4 v8, s[36:39], s64 offen offset:0 lds
    buffer_load_dwordx4 v9, s[36:39], s64 offen offset:1024 lds
    buffer_load_dwordx4 v10, s[36:39], s64 offen offset:2048 lds
    buffer_load_dwordx4 v11, s[36:39], s64 offen offset:3072 lds
    s_add_u32 m0, s21, 0xc000
    s_add_u32 s64, s23, 3
    s_lshl_b32 s64, s64, 15
    buffer_load_dwordx4 v8, s[36:39], s64 offen offset:0 lds
    buffer_load_dwordx4 v9, s[36:39], s64 offen offset:1024 lds
    buffer_load_dwordx4 v10, s[36:39], s64 offen offset:2048 lds
    buffer_load_dwordx4 v11, s[36:39], s64 offen offset:3072 lds
    s_waitcnt vmcnt(12)
    ds_read_b64_tr_b16 v[128:129], v12 offset:0
    ds_read_b64_tr_b16 v[130:131], v12 offset:2048
    ds_read_b64_tr_b16 v[132:133], v13 offset:0
    ds_read_b64_tr_b16 v[134:135], v13 offset:2048
    ds_read_b64_tr_b16 v[136:137], v14 offset:0
    ds_read_b64_tr_b16 v[138:139], v14 offset:2048
    ds_read_b64_tr_b16 v[140:141], v15 offset:0
    ds_read_b64_tr_b16 v[142:143], v15 offset:2048
    s_waitcnt vmcnt(8)
    ds_read_b64_tr_b16 v[144:145], v12 offset:16384
    ds_read_b64_tr_b16 v[146:147], v12 offset:18432
    ds_read_b64_tr_b16 v[148:149], v13 offset:16384
    ds_read_b64_tr_b16 v[150:151], v13 offset:18432
    ds_read_b64_tr_b16 v[152:153], v14 offset:16384
    ds_read_b64_tr_b16 v[154:155], v14 offset:18432
    ds_read_b64_tr_b16 v[156:157], v15 offset:16384
    ds_read_b64_tr_b16 v[158:159], v15 offset:18432
    s_waitcnt vmcnt(4)
    ds_read_b64_tr_b16 v[160:161], v12 offset:32768
    ds_read_b64_tr_b16 v[162:163], v12 offset:34816
    ds_read_b64_tr_b16 v[164:165], v13 offset:32768
    ds_read_b64_tr_b16 v[166:167], v13 offset:34816
    ds_read_b64_tr_b16 v[168:169], v14 offset:32768
    ds_read_b64_tr_b16 v[170:171], v14 offset:34816
    ds_read_b64_tr_b16 v[172:173], v15 offset:32768
    ds_read_b64_tr_b16 v[174:175], v15 offset:34816
    s_waitcnt vmcnt(0)
    ds_read_b64_tr_b16 v[176:177], v12 offset:49152
    ds_read_b64_tr_b16 v[178:179], v12 offset:51200
    ds_read_b64_tr_b16 v[180:181], v13 offset:49152
    ds_read_b64_tr_b16 v[182:183], v13 offset:51200
    ds_read_b64_tr_b16 v[184:185], v14 offset:49152
    ds_read_b64_tr_b16 v[186:187], v14 offset:51200
    ds_read_b64_tr_b16 v[188:189], v15 offset:49152
    ds_read_b64_tr_b16 v[190:191], v15 offset:51200
    s_xor_b32 s64, s58, 1
    s_lshl_b32 s12, s64, 3
    s_add_u32 s12, s12, s59
    s_lshl_b32 s12, s12, 14
    s_lshl_b32 s65, s60, 12
    s_add_u32 s12, s12, s65
    s_add_u32 s12, s12, 11534336
    s_and_b32 s64, s64, 1
    s_lshl_b32 s64, s64, 5
    s_lshl_b32 s65, s59, 2
    s_add_u32 s64, s64, s65
    s_add_u32 s64, s64, s60
    s_lshl_b32 s64, s64, 2
    s_lshr_b32 s65, s58, 1
    s_lshl_b32 s65, s65, 8
    s_add_u32 s13, s64, s65
    s_add_u32 s13, s13, 9478144
    s_lshl_b32 s64, s60, 14
    s_add_u32 s64, s64, 94208
    v_lshlrev_b32 v97, 4, v0
    v_add_u32 v96, s64, v97
    s_lshl_b32 s65, s60, 2
    s_mov_b32 s70, 40000
    v_mov_b32 v98, s65
CW_37:
    ds_read_b32 v99, v98 offset:48
    s_waitcnt lgkmcnt(0)
    v_readfirstlane_b32 s71, v99
    s_nop 0
    s_cmp_ge_u32 s71, 4
    s_cbranch_scc1 CWD_38
    s_sub_u32 s70, s70, 1
    s_cbranch_scc1 CWD_38
    s_sleep 1
    s_branch CW_37
CWD_38:
    ds_read_b128 v[16:19], v96 offset:0
    ds_read_b128 v[20:23], v96 offset:4096
    ds_read_b128 v[24:27], v96 offset:8192
    ds_read_b128 v[28:31], v96 offset:12288
    ds_read_b128 v[32:35], v96 offset:1024
    ds_read_b128 v[36:39], v96 offset:5120
    ds_read_b128 v[40:43], v96 offset:9216
    ds_read_b128 v[44:47], v96 offset:13312
    ds_read_b128 v[48:51], v96 offset:2048
    ds_read_b128 v[52:55], v96 offset:6144
    ds_read_b128 v[56:59], v96 offset:10240
    ds_read_b128 v[60:63], v96 offset:14336
    ds_read_b128 v[64:67], v96 offset:3072
    ds_read_b128 v[68:71], v96 offset:7168
    ds_read_b128 v[72:75], v96 offset:11264
    ds_read_b128 v[76:79], v96 offset:15360
    s_waitcnt lgkmcnt(12)
    v_add_f32 v16, v16, v20
    v_add_f32 v24, v24, v28
    v_add_f32 v17, v17, v21
    v_add_f32 v25, v25, v29
    v_add_f32 v18, v18, v22
    v_add_f32 v26, v26, v30
    v_add_f32 v19, v19, v23
    v_add_f32 v27, v27, v31
    v_add_f32 v16, v16, v24
    v_add_f32 v17, v17, v25
    v_add_f32 v18, v18, v26
    v_add_f32 v19, v19, v27
    buffer_store_dwordx4 v[16:19], v97, s[40:43], s12 offen offset:0 sc1
    s_waitcnt lgkmcnt(8)
    v_add_f32 v32, v32, v36
    v_add_f32 v40, v40, v44
    v_add_f32 v33, v33, v37
    v_add_f32 v41, v41, v45
    v_add_f32 v34, v34, v38
    v_add_f32 v42, v42, v46
    v_add_f32 v35, v35, v39
    v_add_f32 v43, v43, v47
    v_add_f32 v32, v32, v40
    v_add_f32 v33, v33, v41
    v_add_f32 v34, v34, v42
    v_add_f32 v35, v35, v43
    buffer_store_dwordx4 v[32:35], v97, s[40:43], s12 offen offset:1024 sc1
    s_waitcnt lgkmcnt(4)
    v_add_f32 v48, v48, v52
    v_add_f32 v56, v56, v60
    v_add_f32 v49, v49, v53
    v_add_f32 v57, v57, v61
    v_add_f32 v50, v50, v54
    v_add_f32 v58, v58, v62
    v_add_f32 v51, v51, v55
    v_add_f32 v59, v59, v63
    v_add_f32 v48, v48, v56
    v_add_f32 v49, v49, v57
    v_add_f32 v50, v50, v58
    v_add_f32 v51, v51, v59
    buffer_store_dwordx4 v[48:51], v97, s[40:43], s12 offen offset:2048 sc1
    s_waitcnt lgkmcnt(0)
    v_mov_b32 v98, 0
    v_mov_b32 v99, 1
    s_mov_b64 exec, 1
    ds_add_u32 v98, v99 offset:12
    s_mov_b64 exec, -1
    v_add_f32 v64, v64, v68
    v_add_f32 v72, v72, v76
    v_add_f32 v65, v65, v69
    v_add_f32 v73, v73, v77
    v_add_f32 v66, v66, v70
    v_add_f32 v74, v74, v78
    v_add_f32 v67, v67, v71
    v_add_f32 v75, v75, v79
    v_add_f32 v64, v64, v72
    v_add_f32 v65, v65, v73
    v_add_f32 v66, v66, v74
    v_add_f32 v67, v67, v75
    buffer_store_dwordx4 v[64:67], v97, s[40:43], s12 offen offset:3072 sc1
    s_waitcnt lgkmcnt(0)
    s_branch L_P2C
L_STATS:
    s_waitcnt vmcnt(1)
    v_lshlrev_b32 v184, 16, v176
    v_and_b32 v185, 0xffff0000, v176
    v_lshlrev_b32 v186, 16, v177
    v_and_b32 v187, 0xffff0000, v177
    v_lshlrev_b32 v188, 16, v178
    v_and_b32 v189, 0xffff0000, v178
    v_lshlrev_b32 v190, 16, v179
    v_and_b32 v191, 0xffff0000, v179
    v_lshlrev_b32 v192, 16, v180
    v_and_b32 v193, 0xffff0000, v180
    v_lshlrev_b32 v194, 16, v181
    v_and_b32 v195, 0xffff0000, v181
    v_lshlrev_b32 v196, 16, v182
    v_and_b32 v197, 0xffff0000, v182
    v_lshlrev_b32 v198, 16, v183
    v_and_b32 v199, 0xffff0000, v183
    v_pk_add_f32 v[176:177], v[184:185], v[186:187]
    v_pk_add_f32 v[178:179], v[188:189], v[190:191]
    v_pk_add_f32 v[180:181], v[192:193], v[194:195]
    v_pk_add_f32 v[182:183], v[196:197], v[198:199]
    v_pk_add_f32 v[176:177], v[176:177], v[178:179]
    v_pk_add_f32 v[180:181], v[180:181], v[182:183]
    v_pk_add_f32 v[176:177], v[176:177], v[180:181]
    v_add_f32 v200, v176, v177
    s_nop 1
    v_add_f32_dpp v200, v200, v200 row_ror:8 row_mask:0xf bank_mask:0xf
    s_nop 1
    v_add_f32_dpp v200, v200, v200 row_ror:4 row_mask:0xf bank_mask:0xf
    s_nop 1
    v_add_f32_dpp v200, v200, v200 row_ror:2 row_mask:0xf bank_mask:0xf
    s_nop 1
    v_add_f32_dpp v200, v200, v200 row_ror:1 row_mask:0xf bank_mask:0xf
    v_mov_b32 v201, v200
    s_nop 1
    v_permlane16_swap_b32 v200, v201
    v_add_f32 v200, v200, v201
    v_mul_f32 v202, 0x3b000000, v200
    v_pk_add_f32 v[184:185], v[184:185], v[202:203] op_sel_hi:[1,0] neg_lo:[0,1] neg_hi:[0,1]
    v_pk_add_f32 v[186:187], v[186:187], v[202:203] op_sel_hi:[1,0] neg_lo:[0,1] neg_hi:[0,1]
    v_pk_add_f32 v[188:189], v[188:189], v[202:203] op_sel_hi:[1,0] neg_lo:[0,1] neg_hi:[0,1]
    v_pk_add_f32 v[190:191], v[190:191], v[202:203] op_sel_hi:[1,0] neg_lo:[0,1] neg_hi:[0,1]
    v_pk_add_f32 v[192:193], v[192:193], v[202:203] op_sel_hi:[1,0] neg_lo:[0,1] neg_hi:[0,1]
    v_pk_add_f32 v[194:195], v[194:195], v[202:203] op_sel_hi:[1,0] neg_lo:[0,1] neg_hi:[0,1]
    v_pk_add_f32 v[196:197], v[196:197], v[202:203] op_sel_hi:[1,0] neg_lo:[0,1] neg_hi:[0,1]
    v_pk_add_f32 v[198:199], v[198:199], v[202:203] op_sel_hi:[1,0] neg_lo:[0,1] neg_hi:[0,1]
    v_pk_mul_f32 v[176:177], v[184:185], v[184:185]
    v_pk_mul_f32 v[178:179], v[186:187], v[186:187]
    v_pk_fma_f32 v[176:177], v[188:189], v[188:189], v[176:177]
    v_pk_fma_f32 v[178:179], v[190:191], v[190:191], v[178:179]
    v_pk_fma_f32 v[176:177], v[192:193], v[192:193], v[176:177]
    v_pk_fma_f32 v[178:179], v[194:195], v[194:195], v[178:179]
    v_pk_fma_f32 v[176:177], v[196:197], v[196:197], v[176:177]
    v_pk_fma_f32 v[178:179], v[198:199], v[198:199], v[178:179]
    v_pk_add_f32 v[176:177], v[176:177], v[178:179]
    v_add_f32 v200, v176, v177
    s_nop 1
    v_add_f32_dpp v200, v200, v200 row_ror:8 row_mask:0xf bank_mask:0xf
    s_nop 1
    v_add_f32_dpp v200, v200, v200 row_ror:4 row_mask:0xf bank_mask:0xf
    s_nop 1
    v_add_f32_dpp v200, v200, v200 row_ror:2 row_mask:0xf bank_mask:0xf
    s_nop 1
    v_add_f32_dpp v200, v200, v200 row_ror:1 row_mask:0xf bank_mask:0xf
    v_mov_b32 v201, v200
    s_nop 1
    v_permlane16_swap_b32 v200, v201
    v_add_f32 v200, v200, v201
    v_mul_f32 v200, 0x3b000000, v200
    v_cvt_pk_bf16_f32 v200, v200, v200
    v_lshlrev_b32 v200, 16, v200
    v_cvt_pk_bf16_f32 v202, v202, v202
    v_lshlrev_b32 v202, 16, v202
    v_add_f32 v200, 0x3727c5ac, v200
    v_cvt_pk_bf16_f32 v200, v200, v200
    v_lshlrev_b32 v200, 16, v200
    v_sqrt_f32 v200, v200
    s_nop 0
    v_cvt_pk_bf16_f32 v200, v200, v200
    v_lshlrev_b32 v200, 16, v200
    v_rcp_f32 v203, v200
    v_xor_b32 v202, 0x80000000, v202
    v_lshrrev_b32 v201, 5, v0
    s_lshl_b32 s64, s60, 4
    v_lshl_add_u32 v201, v201, 3, s64
    ds_write_b64 v201, v[202:203] offset:64
    s_waitcnt lgkmcnt(0)
    s_setpc_b64 s[8:9]
L_C:
    s_or_b32 s64, s2, s3
    s_cmp_lg_u32 s64, 0
    s_cbranch_scc1 L_C1
    s_memrealtime s[64:65]
    s_waitcnt lgkmcnt(0)
    s_or_b32 s64, s64, 1
    v_mov_b32 v4, s64
    v_mov_b32 v5, 0
    s_mov_b64 exec, 1
    buffer_store_dword v4, v5, s[44:47], 0 offen sc1
    s_mov_b64 exec, -1
L_C1:
    v_lshrrev_b32 v12, 5, v0
    s_lshl_b32 s64, s61, 8
    s_lshl_b32 s65, s57, 3
    s_add_u32 s64, s64, s65
    s_lshl_b32 s65, s60, 1
    s_add_u32 s64, s64, s65
    v_add_u32 v12, s64, v12
    v_lshlrev_b32 v12, 10, v12
    v_and_b32 v13, 31, v0
    v_lshl_add_u32 v12, v13, 4, v12
    s_waitcnt lgkmcnt(0)
    buffer_load_dwordx4 v[176:179], v12, s[24:27], 0 offen
    buffer_load_dwordx4 v[180:183], v12, s[24:27], 0 offen offset:512
    s_cmp_ge_u32 s57, 16
    s_cbranch_scc1 L_MLP_C
L_ATT_C:
    s_and_b32 s16, s60, 1
    s_lshr_b32 s17, s60, 1
    s_lshl_b32 s12, s57, 1
    s_add_u32 s12, s12, s16
    v_and_b32 v12, 15, v0
    v_lshlrev_b32 v14, 2, v12
    v_lshlrev_b32 v12, 1, v12
    v_lshrrev_b32 v13, 4, v0
    v_lshl_or_b32 v12, v13, 7, v12
    s_lshl_b32 s64, s12, 9
    s_waitcnt lgkmcnt(0)
    buffer_load_ushort v224, v12, s[52:55], s64 offen
    buffer_load_ushort v226, v12, s[52:55], s64 offen offset:32
    buffer_load_ushort v225, v12, s[52:55], s64 offen offset:64
    buffer_load_ushort v227, v12, s[52:55], s64 offen offset:96
    s_lshl_b32 s64, s17, 14
    s_add_u32 s64, s64, 4096
    v_and_b32 v12, 15, v0
    v_lshlrev_b32 v1, 7, v12
    v_lshrrev_b32 v12, 1, v12
    v_lshrrev_b32 v2, 4, v0
    v_xor_b32 v12, v12, v2
    v_lshl_or_b32 v1, v12, 4, v1
    v_add_u32 v1, s64, v1
    v_xor_b32 v2, 64, v1
    v_lshrrev_b32 v12, 4, v0
    v_lshlrev_b32 v3, 9, v12
    v_and_b32 v12, 1, v12
    v_lshl_or_b32 v3, v12, 5, v3
    v_bfe_u32 v12, v0, 2, 2
    v_lshl_or_b32 v3, v12, 6, v3
    v_and_b32 v12, 3, v0
    v_lshl_or_b32 v3, v12, 3, v3
    s_lshl_b32 s64, s16, 5
    v_xor_b32 v3, s64, v3
    v_add_u32 v3, 36864, v3
    v_mov_b32 v220, 0
    v_mov_b32 v221, 0
    v_mov_b32 v222, 0
    v_mov_b32 v223, 0
    s_nop 1
    v_mfma_f32_32x32x16_bf16 v[16:31], v[220:223], v[220:223], 0
    v_mfma_f32_32x32x16_bf16 v[32:47], v[220:223], v[220:223], 0
    v_mfma_f32_32x32x16_bf16 v[112:127], v[220:223], v[220:223], 0
    v_mfma_f32_32x32x16_bf16 v[128:143], v[220:223], v[220:223], 0
    v_mfma_f32_32x32x16_bf16 v[144:159], v[220:223], v[220:223], 0
    v_mfma_f32_32x32x16_bf16 v[160:175], v[220:223], v[220:223], 0
    v_and_b32 v13, 15, v0
    v_lshlrev_b32 v6, 6, v13
    v_bfe_u32 v12, v0, 2, 1
    v_lshlrev_b32 v12, 1, v12
    v_bfe_u32 v13, v0, 3, 1
    v_or_b32 v12, v12, v13
    v_lshrrev_b32 v13, 4, v0
    v_xor_b32 v12, v12, v13
    v_lshl_or_b32 v6, v12, 4, v6
    s_lshl_b32 s64, s16, 14
    s_add_u32 s64, s64, 4096
    s_lshl_b32 s65, s17, 13
    s_add_u32 s66, s64, s65
    v_add_u32 v6, s66, v6
    v_lshlrev_b32 v7, 4, v13
    s_lshl_b32 s67, s16, 6
    v_add_u32 v8, s67, v7
    v_add_u32 v11, s67, v14
    s_lshl_b32 s67, s17, 9
    v_add_u32 v7, s67, v7
    v_add_u32 v14, s67, v14
    v_lshrrev_b32 v12, 2, v0
    v_lshlrev_b32 v9, 6, v12
    v_bfe_u32 v12, v0, 4, 1
    v_lshlrev_b32 v12, 1, v12
    v_lshrrev_b32 v13, 5, v0
    v_or_b32 v12, v12, v13
    v_and_b32 v13, 3, v0
    v_xor_b32 v12, v12, v13
    v_lshl_or_b32 v9, v12, 4, v9
    s_lshl_b32 s67, s17, 3
    s_add_u32 s66, s66, s67
    v_add_u32 v9, s66, v9
    v_xor_b32 v10, 8192, v9
    s_lshl_b32 s13, s12, 14
    s_lshl_b32 s64, s17, 13
    s_add_u32 s13, s13, s64
    s_add_u32 s13, s13, 9502720
    s_lshl_b32 s64, s61, 10
    s_add_u32 s14, s13, s64
    s_add_u32 s64, s56, s17
    s_lshl_b32 s65, s64, 8
    s_lshl_b32 s66, s12, 2
    s_add_u32 s65, s65, s66
    s_add_u32 s18, s65, 9474048
    s_mul_i32 s19, s64, 576
    s_add_u32 s19, s19, s57
    s_add_u32 s19, s19, 56
    s_lshl_b32 s19, s19, 10
    s_lshl_b32 s64, s16, 3
    s_add_u32 s19, s19, s64
    v_mov_b32 v220, 0x3f803f80
    v_mov_b32 v221, 0x3f803f80
    v_mov_b32 v222, 0x3f803f80
    v_mov_b32 v223, 0x3f803f80
    s_lshl_b32 s64, s57, 2
    s_add_u32 s64, s64, s60
    v_lshlrev_b32 v254, 10, v0
    v_add_u32 v254, 384, v254
    s_mul_i32 s65, s64, 12288
    s_mov_b64 exec, 0xfff
    buffer_load_dword v255, v254, s[28:31], s65 offen
    s_mov_b64 exec, -1
    s_call_b64 s[8:9], L_STATS
    v_lshl_or_b32 v224, v226, 16, v224
    v_lshl_or_b32 v225, v227, 16, v225
    s_barrier
    ds_read_b64_tr_b16 v[180:181], v3 offset:4096
    ds_read_b64_tr_b16 v[182:183], v3 offset:4352
    ds_read_b64_tr_b16 v[184:185], v3 offset:8192
    ds_read_b64_tr_b16 v[186:187], v3 offset:8448
    ds_read_b64_tr_b16 v[176:177], v3 offset:0
    ds_read_b64_tr_b16 v[178:179], v3 offset:256
    ds_read_b128 v[48:51], v1 offset:0
    ds_read_b128 v[52:55], v1 offset:2048
    ds_read_b128 v[56:59], v1 offset:4096
    ds_read_b128 v[60:63], v1 offset:6144
    ds_read_b128 v[64:67], v1 offset:8192
    ds_read_b128 v[68:71], v1 offset:10240
    ds_read_b128 v[72:75], v1 offset:12288
    ds_read_b128 v[76:79], v1 offset:14336
    s_mov_b32 s66, 0
    s_mov_b32 s67, 45056
    s_mov_b32 s68, 45056
    s_mov_b32 s69, 4294877184
L_AC_MID:
    s_waitcnt lgkmcnt(7)
    v_mfma_f32_16x16x32_bf16 v[16:19], v[180:183], v[48:51], v[16:19]
    ds_read_b64_tr_b16 v[192:193], v3 offset:6144
    v_mfma_f32_16x16x32_bf16 v[112:115], v[48:51], v[184:187], v[112:115]
    ds_read_b64_tr_b16 v[194:195], v3 offset:6400
    v_mfma_f32_16x16x32_bf16 v[144:147], v[176:179], v[48:51], v[144:147]
    ds_read_b64_tr_b16 v[196:197], v3 offset:10240
    s_waitcnt lgkmcnt(9)
    v_mfma_f32_16x16x32_bf16 v[20:23], v[180:183], v[52:55], v[20:23]
    ds_read_b64_tr_b16 v[198:199], v3 offset:10496
    v_mfma_f32_16x16x32_bf16 v[116:119], v[52:55], v[184:187], v[116:119]
    ds_read_b64_tr_b16 v[188:189], v3 offset:2048
    v_mfma_f32_16x16x32_bf16 v[148:151], v[176:179], v[52:55], v[148:151]
    ds_read_b64_tr_b16 v[190:191], v3 offset:2304
    s_waitcnt lgkmcnt(11)
    v_mfma_f32_16x16x32_bf16 v[24:27], v[180:183], v[56:59], v[24:27]
    ds_read_b128 v[80:83], v2 offset:0
    v_mfma_f32_16x16x32_bf16 v[120:123], v[56:59], v[184:187], v[120:123]
    ds_read_b128 v[84:87], v2 offset:2048
    v_mfma_f32_16x16x32_bf16 v[152:155], v[176:179], v[56:59], v[152:155]
    ds_read_b128 v[88:91], v2 offset:4096
    s_waitcnt lgkmcnt(13)
    v_mfma_f32_16x16x32_bf16 v[28:31], v[180:183], v[60:63], v[28:31]
    ds_read_b128 v[92:95], v2 offset:6144
    v_mfma_f32_16x16x32_bf16 v[124:127], v[60:63], v[184:187], v[124:127]
    ds_read_b128 v[96:99], v2 offset:8192
    v_mfma_f32_16x16x32_bf16 v[156:159], v[176:179], v[60:63], v[156:159]
    ds_read_b128 v[100:103], v2 offset:10240
    s_waitcnt lgkmcnt(14)
    v_mfma_f32_16x16x32_bf16 v[32:35], v[180:183], v[64:67], v[32:35]
    ds_read_b128 v[104:107], v2 offset:12288
    v_mfma_f32_16x16x32_bf16 v[128:131], v[64:67], v[184:187], v[128:131]
    ds_read_b128 v[108:111], v2 offset:14336
    v_mfma_f32_16x16x32_bf16 v[160:163], v[176:179], v[64:67], v[160:163]
    v_add_u32 v1, s67, v1
    v_mfma_f32_16x16x32_bf16 v[36:39], v[180:183], v[68:71], v[36:39]
    v_add_u32 v2, s67, v2
    v_mfma_f32_16x16x32_bf16 v[132:135], v[68:71], v[184:187], v[132:135]
    v_add_u32 v3, s67, v3
    v_mfma_f32_16x16x32_bf16 v[164:167], v[176:179], v[68:71], v[164:167]
    s_waitcnt lgkmcnt(0)
    s_barrier
    v_mfma_f32_16x16x32_bf16 v[40:43], v[180:183], v[72:75], v[40:43]
    v_mfma_f32_16x16x32_bf16 v[136:139], v[72:75], v[184:187], v[136:139]
    v_mfma_f32_16x16x32_bf16 v[168:171], v[176:179], v[72:75], v[168:171]
    v_mfma_f32_16x16x32_bf16 v[44:47], v[180:183], v[76:79], v[44:47]
    v_mfma_f32_16x16x32_bf16 v[140:143], v[76:79], v[184:187], v[140:143]
    v_mfma_f32_16x16x32_bf16 v[172:175], v[176:179], v[76:79], v[172:175]
    v_mfma_f32_16x16x32_bf16 v[16:19], v[192:195], v[80:83], v[16:19]
    ds_read_b64_tr_b16 v[180:181], v3 offset:4096
    v_mfma_f32_16x16x32_bf16 v[112:115], v[80:83], v[196:199], v[112:115]
    ds_read_b64_tr_b16 v[182:183], v3 offset:4352
    v_mfma_f32_16x16x32_bf16 v[144:147], v[188:191], v[80:83], v[144:147]
    ds_read_b64_tr_b16 v[184:185], v3 offset:8192
    v_mfma_f32_16x16x32_bf16 v[20:23], v[192:195], v[84:87], v[20:23]
    ds_read_b64_tr_b16 v[186:187], v3 offset:8448
    v_mfma_f32_16x16x32_bf16 v[116:119], v[84:87], v[196:199], v[116:119]
    ds_read_b64_tr_b16 v[176:177], v3 offset:0
    v_mfma_f32_16x16x32_bf16 v[148:151], v[188:191], v[84:87], v[148:151]
    ds_read_b64_tr_b16 v[178:179], v3 offset:256
    v_mfma_f32_16x16x32_bf16 v[24:27], v[192:195], v[88:91], v[24:27]
    ds_read_b128 v[48:51], v1 offset:0
    v_mfma_f32_16x16x32_bf16 v[120:123], v[88:91], v[196:199], v[120:123]
    ds_read_b128 v[52:55], v1 offset:2048
    v_mfma_f32_16x16x32_bf16 v[152:155], v[188:191], v[88:91], v[152:155]
    ds_read_b128 v[56:59], v1 offset:4096
    v_mfma_f32_16x16x32_bf16 v[28:31], v[192:195], v[92:95], v[28:31]
    ds_read_b128 v[60:63], v1 offset:6144
    v_mfma_f32_16x16x32_bf16 v[124:127], v[92:95], v[196:199], v[124:127]
    ds_read_b128 v[64:67], v1 offset:8192
    v_mfma_f32_16x16x32_bf16 v[156:159], v[188:191], v[92:95], v[156:159]
    ds_read_b128 v[68:71], v1 offset:10240
    v_mfma_f32_16x16x32_bf16 v[32:35], v[192:195], v[96:99], v[32:35]
    ds_read_b128 v[72:75], v1 offset:12288
    v_mfma_f32_16x16x32_bf16 v[128:131], v[96:99], v[196:199], v[128:131]
    ds_read_b128 v[76:79], v1 offset:14336
    v_mfma_f32_16x16x32_bf16 v[160:163], v[188:191], v[96:99], v[160:163]
    s_mov_b32 s64, s67
    v_mfma_f32_16x16x32_bf16 v[36:39], v[192:195], v[100:103], v[36:39]
    s_mov_b32 s67, s68
    v_mfma_f32_16x16x32_bf16 v[132:135], v[100:103], v[196:199], v[132:135]
    s_mov_b32 s68, s69
    v_mfma_f32_16x16x32_bf16 v[164:167], v[188:191], v[100:103], v[164:167]
    s_mov_b32 s69, s64
    v_mfma_f32_16x16x32_bf16 v[40:43], v[192:195], v[104:107], v[40:43]
    s_add_u32 s66, s66, 1
    v_mfma_f32_16x16x32_bf16 v[136:139], v[104:107], v[196:199], v[136:139]
    s_cmp_eq_u32 s66, 6
    v_mfma_f32_16x16x32_bf16 v[168:171], v[188:191], v[104:107], v[168:171]
    v_mfma_f32_16x16x32_bf16 v[44:47], v[192:195], v[108:111], v[44:47]
    v_mfma_f32_16x16x32_bf16 v[140:143], v[108:111], v[196:199], v[140:143]
    v_mfma_f32_16x16x32_bf16 v[172:175], v[188:191], v[108:111], v[172:175]
    s_cbranch_scc0 L_AC_MID
    s_waitcnt lgkmcnt(7)
    v_mfma_f32_16x16x32_bf16 v[16:19], v[180:183], v[48:51], v[16:19]
    ds_read_b64_tr_b16 v[192:193], v3 offset:6144
    v_mfma_f32_16x16x32_bf16 v[112:115], v[48:51], v[184:187], v[112:115]
    ds_read_b64_tr_b16 v[194:195], v3 offset:6400
    v_mfma_f32_16x16x32_bf16 v[144:147], v[176:179], v[48:51], v[144:147]
    ds_read_b64_tr_b16 v[196:197], v3 offset:10240
    s_waitcnt lgkmcnt(9)
    v_mfma_f32_16x16x32_bf16 v[20:23], v[180:183], v[52:55], v[20:23]
    ds_read_b64_tr_b16 v[198:199], v3 offset:10496
    v_mfma_f32_16x16x32_bf16 v[116:119], v[52:55], v[184:187], v[116:119]
    ds_read_b64_tr_b16 v[188:189], v3 offset:2048
    v_mfma_f32_16x16x32_bf16 v[148:151], v[176:179], v[52:55], v[148:151]
    ds_read_b64_tr_b16 v[190:191], v3 offset:2304
    s_waitcnt lgkmcnt(11)
    v_mfma_f32_16x16x32_bf16 v[24:27], v[180:183], v[56:59], v[24:27]
    ds_read_b128 v[80:83], v2 offset:0
    v_mfma_f32_16x16x32_bf16 v[120:123], v[56:59], v[184:187], v[120:123]
    ds_read_b128 v[84:87], v2 offset:2048
    v_mfma_f32_16x16x32_bf16 v[152:155], v[176:179], v[56:59], v[152:155]
    ds_read_b128 v[88:91], v2 offset:4096
    s_waitcnt lgkmcnt(13)
    v_mfma_f32_16x16x32_bf16 v[28:31], v[180:183], v[60:63], v[28:31]
    ds_read_b128 v[92:95], v2 offset:6144
    v_mfma_f32_16x16x32_bf16 v[124:127], v[60:63], v[184:187], v[124:127]
    ds_read_b128 v[96:99], v2 offset:8192
    v_mfma_f32_16x16x32_bf16 v[156:159], v[176:179], v[60:63], v[156:159]
    ds_read_b128 v[100:103], v2 offset:10240
    s_waitcnt lgkmcnt(14)
    v_mfma_f32_16x16x32_bf16 v[32:35], v[180:183], v[64:67], v[32:35]
    ds_read_b128 v[104:107], v2 offset:12288
    v_mfma_f32_16x16x32_bf16 v[128:131], v[64:67], v[184:187], v[128:131]
    ds_read_b128 v[108:111], v2 offset:14336
    v_mfma_f32_16x16x32_bf16 v[160:163], v[176:179], v[64:67], v[160:163]
    v_add_u32 v1, s67, v1
    v_mfma_f32_16x16x32_bf16 v[36:39], v[180:183], v[68:71], v[36:39]
    v_add_u32 v2, s67, v2
    v_mfma_f32_16x16x32_bf16 v[132:135], v[68:71], v[184:187], v[132:135]
    v_add_u32 v3, s67, v3
    v_mfma_f32_16x16x32_bf16 v[164:167], v[176:179], v[68:71], v[164:167]
    s_waitcnt lgkmcnt(0)
    s_barrier
    ds_read_b128 v[200:203], v8 offset:3328
    ds_read_b32 v210, v14 offset:1024
    v_mfma_f32_16x16x32_bf16 v[40:43], v[180:183], v[72:75], v[40:43]
    ds_read_b32 v211, v14 offset:1088
    ds_read_b32 v212, v14 offset:1152
    v_mfma_f32_16x16x32_bf16 v[136:139], v[72:75], v[184:187], v[136:139]
    ds_read_b32 v213, v14 offset:1216
    ds_read_b32 v214, v14 offset:1280
    v_mfma_f32_16x16x32_bf16 v[168:171], v[176:179], v[72:75], v[168:171]
    ds_read_b32 v215, v14 offset:1344
    ds_read_b32 v216, v14 offset:1408
    v_mfma_f32_16x16x32_bf16 v[44:47], v[180:183], v[76:79], v[44:47]
    ds_read_b32 v217, v14 offset:1472
    ds_read_b128 v[204:207], v8 offset:3072
    v_mfma_f32_16x16x32_bf16 v[140:143], v[76:79], v[184:187], v[140:143]
    ds_read_b32 v208, v11 offset:3584
    v_mov_b32 v252, 0
    ds_read_b64 v[252:253], v252 offset:0
    v_mfma_f32_16x16x32_bf16 v[172:175], v[176:179], v[76:79], v[172:175]
    s_setprio 3
    v_mfma_f32_16x16x32_bf16 v[16:19], v[192:195], v[80:83], v[16:19]
    ds_read_b64_tr_b16 v[180:181], v3 offset:4096
    v_mfma_f32_16x16x32_bf16 v[112:115], v[80:83], v[196:199], v[112:115]
    ds_read_b64_tr_b16 v[182:183], v3 offset:4352
    v_mfma_f32_16x16x32_bf16 v[144:147], v[188:191], v[80:83], v[144:147]
    ds_read_b64_tr_b16 v[184:185], v3 offset:8192
    v_mfma_f32_16x16x32_bf16 v[20:23], v[192:195], v[84:87], v[20:23]
    ds_read_b64_tr_b16 v[186:187], v3 offset:8448
    s_waitcnt lgkmcnt(12)
    v_fmac_f32 v24, v200, v212
    v_fmac_f32 v25, v201, v212
    v_mfma_f32_16x16x32_bf16 v[116:119], v[84:87], v[196:199], v[116:119]
    ds_read_b64_tr_b16 v[176:177], v3 offset:0
    s_waitcnt lgkmcnt(12)
    v_fmac_f32 v28, v200, v213
    v_fmac_f32 v29, v201, v213
    v_mfma_f32_16x16x32_bf16 v[148:151], v[188:191], v[84:87], v[148:151]
    ds_read_b64_tr_b16 v[178:179], v3 offset:256
    v_fmac_f32 v16, v200, v210
    v_fmac_f32 v17, v201, v210
    v_mfma_f32_16x16x32_bf16 v[24:27], v[192:195], v[88:91], v[24:27]
    ds_read_b128 v[48:51], v1 offset:0
    s_waitcnt lgkmcnt(13)
    v_fmac_f32 v32, v200, v214
    v_fmac_f32 v33, v201, v214
    v_mfma_f32_16x16x32_bf16 v[120:123], v[88:91], v[196:199], v[120:123]
    ds_read_b128 v[52:55], v1 offset:2048
    s_waitcnt lgkmcnt(13)
    v_fmac_f32 v36, v200, v215
    v_fmac_f32 v37, v201, v215
    v_mfma_f32_16x16x32_bf16 v[152:155], v[188:191], v[88:91], v[152:155]
    ds_read_b128 v[56:59], v1 offset:4096
    v_fmac_f32 v20, v200, v211
    v_fmac_f32 v21, v201, v211
    v_mfma_f32_16x16x32_bf16 v[28:31], v[192:195], v[92:95], v[28:31]
    ds_read_b128 v[60:63], v1 offset:6144
    s_waitcnt lgkmcnt(14)
    v_fmac_f32 v40, v200, v216
    v_fmac_f32 v41, v201, v216
    v_mfma_f32_16x16x32_bf16 v[124:127], v[92:95], v[196:199], v[124:127]
    ds_read_b128 v[64:67], v1 offset:8192
    s_waitcnt lgkmcnt(14)
    v_fmac_f32 v44, v200, v217
    v_fmac_f32 v45, v201, v217
    v_mfma_f32_16x16x32_bf16 v[156:159], v[188:191], v[92:95], v[156:159]
    ds_read_b128 v[68:71], v1 offset:10240
    v_fmac_f32 v18, v202, v210
    v_fmac_f32 v19, v203, v210
    v_mfma_f32_16x16x32_bf16 v[32:35], v[192:195], v[96:99], v[32:35]
    ds_read_b128 v[72:75], v1 offset:12288
    v_fmac_f32 v22, v202, v211
    v_fmac_f32 v23, v203, v211
    v_mfma_f32_16x16x32_bf16 v[128:131], v[96:99], v[196:199], v[128:131]
    ds_read_b128 v[76:79], v1 offset:14336
    v_fmac_f32 v26, v202, v212
    v_fmac_f32 v27, v203, v212
    v_mfma_f32_16x16x32_bf16 v[160:163], v[188:191], v[96:99], v[160:163]
    v_fmac_f32 v30, v202, v213
    v_fmac_f32 v31, v203, v213
    v_fmac_f32 v42, v202, v216
    v_mfma_f32_16x16x32_bf16 v[36:39], v[192:195], v[100:103], v[36:39]
    v_fmac_f32 v46, v202, v217
    v_fmac_f32 v47, v203, v217
    v_fmac_f32 v43, v203, v216
    v_mfma_f32_16x16x32_bf16 v[132:135], v[100:103], v[196:199], v[132:135]
    v_mfma_f32_16x16x32_bf16 v[164:167], v[188:191], v[100:103], v[164:167]
    v_fmac_f32 v34, v202, v214
    v_fmac_f32 v35, v203, v214
    v_mfma_f32_16x16x32_bf16 v[40:43], v[192:195], v[104:107], v[40:43]
    v_mfma_f32_16x16x32_bf16 v[136:139], v[104:107], v[196:199], v[136:139]
    v_mfma_f32_16x16x32_bf16 v[168:171], v[188:191], v[104:107], v[168:171]
    v_fmac_f32 v38, v202, v215
    v_fmac_f32 v39, v203, v215
    v_mfma_f32_16x16x32_bf16 v[44:47], v[192:195], v[108:111], v[44:47]
    v_mfma_f32_16x16x32_bf16 v[140:143], v[108:111], v[196:199], v[140:143]
    v_mfma_f32_16x16x32_bf16 v[172:175], v[188:191], v[108:111], v[172:175]
    s_waitcnt lgkmcnt(7)
    v_mfma_f32_16x16x32_bf16 v[16:19], v[180:183], v[48:51], v[16:19]
    ds_read_b64_tr_b16 v[192:193], v3 offset:6144
    v_fmac_f32 v144, v204, v210
    s_waitcnt lgkmcnt(7)
    v_mfma_f32_16x16x32_bf16 v[20:23], v[180:183], v[52:55], v[20:23]
    ds_read_b64_tr_b16 v[194:195], v3 offset:6400
    v_fmac_f32 v145, v205, v210
    s_waitcnt lgkmcnt(7)
    v_mfma_f32_16x16x32_bf16 v[24:27], v[180:183], v[56:59], v[24:27]
    ds_read_b64_tr_b16 v[196:197], v3 offset:10240
    v_fmac_f32 v146, v206, v210
    s_waitcnt lgkmcnt(7)
    v_mfma_f32_16x16x32_bf16 v[28:31], v[180:183], v[60:63], v[28:31]
    ds_read_b64_tr_b16 v[198:199], v3 offset:10496
    v_fmac_f32 v147, v207, v210
    s_waitcnt lgkmcnt(7)
    v_mfma_f32_16x16x32_bf16 v[32:35], v[180:183], v[64:67], v[32:35]
    ds_read_b64_tr_b16 v[188:189], v3 offset:2048
    v_fmac_f32 v148, v204, v211
    s_waitcnt lgkmcnt(7)
    v_mfma_f32_16x16x32_bf16 v[36:39], v[180:183], v[68:71], v[36:39]
    ds_read_b64_tr_b16 v[190:191], v3 offset:2304
    v_fmac_f32 v149, v205, v211
    s_waitcnt lgkmcnt(7)
    v_mfma_f32_16x16x32_bf16 v[40:43], v[180:183], v[72:75], v[40:43]
    ds_read_b128 v[80:83], v2 offset:0
    v_fmac_f32 v150, v206, v211
    s_waitcnt lgkmcnt(7)
    v_mfma_f32_16x16x32_bf16 v[44:47], v[180:183], v[76:79], v[44:47]
    ds_read_b128 v[84:87], v2 offset:2048
    v_fmac_f32 v151, v207, v211
    v_mfma_f32_16x16x32_bf16 v[112:115], v[48:51], v[184:187], v[112:115]
    ds_read_b128 v[88:91], v2 offset:4096
    v_fmac_f32 v152, v204, v212
    v_mfma_f32_16x16x32_bf16 v[116:119], v[52:55], v[184:187], v[116:119]
    ds_read_b128 v[92:95], v2 offset:6144
    v_fmac_f32 v153, v205, v212
    v_mfma_f32_16x16x32_bf16 v[120:123], v[56:59], v[184:187], v[120:123]
    ds_read_b128 v[96:99], v2 offset:8192
    v_fmac_f32 v154, v206, v212
    v_mfma_f32_16x16x32_bf16 v[124:127], v[60:63], v[184:187], v[124:127]
    ds_read_b128 v[100:103], v2 offset:10240
    v_fmac_f32 v155, v207, v212
    v_mfma_f32_16x16x32_bf16 v[128:131], v[64:67], v[184:187], v[128:131]
    ds_read_b128 v[104:107], v2 offset:12288
    v_fmac_f32 v156, v204, v213
    v_mfma_f32_16x16x32_bf16 v[132:135], v[68:71], v[184:187], v[132:135]
    ds_read_b128 v[108:111], v2 offset:14336
    v_fmac_f32 v157, v205, v213
    v_mfma_f32_16x16x32_bf16 v[136:139], v[72:75], v[184:187], v[136:139]
    v_fmac_f32 v158, v206, v213
    v_fmac_f32 v159, v207, v213
    v_mfma_f32_16x16x32_bf16 v[140:143], v[76:79], v[184:187], v[140:143]
    v_fmac_f32 v160, v204, v214
    v_fmac_f32 v161, v205, v214
    s_waitcnt lgkmcnt(7)
    v_mfma_f32_16x16x32_bf16 v[16:19], v[192:195], v[80:83], v[16:19]
    v_fmac_f32 v162, v206, v214
    v_fmac_f32 v163, v207, v214
    s_waitcnt lgkmcnt(6)
    v_mfma_f32_16x16x32_bf16 v[20:23], v[192:195], v[84:87], v[20:23]
    v_fmac_f32 v164, v204, v215
    v_fmac_f32 v165, v205, v215
    s_waitcnt lgkmcnt(5)
    v_mfma_f32_16x16x32_bf16 v[24:27], v[192:195], v[88:91], v[24:27]
    v_fmac_f32 v166, v206, v215
    v_fmac_f32 v167, v207, v215
    s_waitcnt lgkmcnt(4)
    v_mfma_f32_16x16x32_bf16 v[28:31], v[192:195], v[92:95], v[28:31]
    v_fmac_f32 v168, v204, v216
    v_fmac_f32 v169, v205, v216
    s_waitcnt lgkmcnt(3)
    v_mfma_f32_16x16x32_bf16 v[32:35], v[192:195], v[96:99], v[32:35]
    v_fmac_f32 v170, v206, v216
    v_fmac_f32 v171, v207, v216
    s_waitcnt lgkmcnt(2)
    v_mfma_f32_16x16x32_bf16 v[36:39], v[192:195], v[100:103], v[36:39]
    v_fmac_f32 v172, v204, v217
    v_fmac_f32 v173, v205, v217
    s_waitcnt lgkmcnt(1)
    v_mfma_f32_16x16x32_bf16 v[40:43], v[192:195], v[104:107], v[40:43]
    v_fmac_f32 v174, v206, v217
    v_fmac_f32 v175, v207, v217
    s_waitcnt lgkmcnt(0)
    v_mfma_f32_16x16x32_bf16 v[44:47], v[192:195], v[108:111], v[44:47]
    v_mfma_f32_16x16x32_bf16 v[144:147], v[176:179], v[48:51], v[144:147]
    v_cvt_pk_bf16_f32 v228, v16, v17
    v_cvt_pk_bf16_f32 v229, v18, v19
    v_cvt_pk_bf16_f32 v230, v20, v21
    v_cvt_pk_bf16_f32 v231, v22, v23
    v_mfma_f32_16x16x32_bf16 v[148:151], v[176:179], v[52:55], v[148:151]
    v_mfma_f32_16x16x16_bf16 v[16:19], v[224:225], v[228:229], 0
    v_cvt_pk_bf16_f32 v232, v24, v25
    v_cvt_pk_bf16_f32 v233, v26, v27
    v_mfma_f32_16x16x16_bf16 v[20:23], v[224:225], v[230:231], 0
    v_mfma_f32_16x16x32_bf16 v[152:155], v[176:179], v[56:59], v[152:155]
    v_cvt_pk_bf16_f32 v234, v28, v29
    v_cvt_pk_bf16_f32 v235, v30, v31
    v_mfma_f32_16x16x16_bf16 v[24:27], v[224:225], v[232:233], 0
    s_nop 0
    ds_write_b128 v6, v[16:19] offset:0
    v_mfma_f32_16x16x32_bf16 v[156:159], v[176:179], v[60:63], v[156:159]
    v_cvt_pk_bf16_f32 v228, v32, v33
    v_cvt_pk_bf16_f32 v229, v34, v35
    v_mfma_f32_16x16x16_bf16 v[28:31], v[224:225], v[234:235], 0
    ds_write_b128 v6, v[20:23] offset:1024
    v_mfma_f32_16x16x32_bf16 v[160:163], v[176:179], v[64:67], v[160:163]
    v_cvt_pk_bf16_f32 v230, v36, v37
    v_cvt_pk_bf16_f32 v231, v38, v39
    v_mfma_f32_16x16x16_bf16 v[32:35], v[224:225], v[228:229], 0
    ds_write_b128 v6, v[24:27] offset:2048
    v_mfma_f32_16x16x32_bf16 v[164:167], v[176:179], v[68:71], v[164:167]
    v_cvt_pk_bf16_f32 v232, v40, v41
    v_cvt_pk_bf16_f32 v233, v42, v43
    v_mfma_f32_16x16x16_bf16 v[36:39], v[224:225], v[230:231], 0
    ds_write_b128 v6, v[28:31] offset:3072
    v_mfma_f32_16x16x32_bf16 v[168:171], v[176:179], v[72:75], v[168:171]
    v_cvt_pk_bf16_f32 v234, v44, v45
    v_cvt_pk_bf16_f32 v235, v46, v47
    v_mfma_f32_16x16x16_bf16 v[40:43], v[224:225], v[232:233], 0
    ds_write_b128 v6, v[32:35] offset:4096
    v_mfma_f32_16x16x32_bf16 v[172:175], v[176:179], v[76:79], v[172:175]
    v_mfma_f32_16x16x16_bf16 v[44:47], v[224:225], v[234:235], 0
    ds_write_b128 v6, v[36:39] offset:5120
    s_nop 3
    ds_write_b128 v6, v[40:43] offset:6144
    s_nop 1
    ds_write_b128 v6, v[44:47] offset:7168
    s_waitcnt lgkmcnt(0)
    s_barrier
    s_setprio 0
    v_mfma_f32_16x16x32_bf16 v[112:115], v[80:83], v[196:199], v[112:115]
    v_mfma_f32_16x16x32_bf16 v[116:119], v[84:87], v[196:199], v[116:119]
    v_mfma_f32_16x16x32_bf16 v[120:123], v[88:91], v[196:199], v[120:123]
    v_mfma_f32_16x16x32_bf16 v[124:127], v[92:95], v[196:199], v[124:127]
    v_mfma_f32_16x16x32_bf16 v[128:131], v[96:99], v[196:199], v[128:131]
    v_mfma_f32_16x16x32_bf16 v[132:135], v[100:103], v[196:199], v[132:135]
    v_mfma_f32_16x16x32_bf16 v[136:139], v[104:107], v[196:199], v[136:139]
    v_mfma_f32_16x16x32_bf16 v[140:143], v[108:111], v[196:199], v[140:143]
    v_mfma_f32_16x16x32_bf16 v[144:147], v[188:191], v[80:83], v[144:147]
    v_mfma_f32_16x16x32_bf16 v[148:151], v[188:191], v[84:87], v[148:151]
    v_mfma_f32_16x16x32_bf16 v[152:155], v[188:191], v[88:91], v[152:155]
    v_mfma_f32_16x16x32_bf16 v[156:159], v[188:191], v[92:95], v[156:159]
    v_mfma_f32_16x16x32_bf16 v[160:163], v[188:191], v[96:99], v[160:163]
    v_mfma_f32_16x16x32_bf16 v[164:167], v[188:191], v[100:103], v[164:167]
    v_mfma_f32_16x16x32_bf16 v[168:171], v[188:191], v[104:107], v[168:171]
    v_mfma_f32_16x16x32_bf16 v[172:175], v[188:191], v[108:111], v[172:175]
    ds_read_b128 v[48:51], v7 offset:1024
    ds_read_b128 v[52:55], v7 offset:2048
    ds_read_b128 v[56:59], v7 offset:1088
    ds_read_b128 v[60:63], v7 offset:2112
    ds_read_b128 v[64:67], v7 offset:1152
    ds_read_b128 v[68:71], v7 offset:2176
    ds_read_b128 v[72:75], v7 offset:1216
    ds_read_b128 v[76:79], v7 offset:2240
    ds_read_b128 v[80:83], v7 offset:1280
    ds_read_b128 v[84:87], v7 offset:2304
    ds_read_b128 v[88:91], v7 offset:1344
    ds_read_b128 v[92:95], v7 offset:2368
    ds_read_b128 v[96:99], v7 offset:1408
    ds_read_b128 v[100:103], v7 offset:2432
    ds_read_b128 v[104:107], v7 offset:1472
    ds_read_b128 v[108:111], v7 offset:2496
    v_readfirstlane_b32 s62, v252
    v_readfirstlane_b32 s63, v253
    v_lshlrev_b32 v3, 4, v0
    s_lshl_b32 s64, s60, 12
    s_xor_b32 s65, s64, 8192
    s_add_u32 s64, s64, 36864
    s_add_u32 s65, s65, 36864
    v_add_u32 v4, s64, v3
    v_add_u32 v5, s65, v3
    s_waitcnt lgkmcnt(14)
    v_pk_fma_f32 v[112:113], v[48:49], v[208:209], v[112:113] op_sel_hi:[1,0,1]
    v_pk_fma_f32 v[114:115], v[50:51], v[208:209], v[114:115] op_sel_hi:[1,0,1]
    v_pk_mul_f32 v[112:113], v[112:113], v[52:53]
    v_pk_mul_f32 v[114:115], v[114:115], v[54:55]
    v_cvt_pk_bf16_f32 v236, v112, v113
    v_cvt_pk_bf16_f32 v237, v114, v115
    s_waitcnt lgkmcnt(12)
    v_pk_fma_f32 v[116:117], v[56:57], v[208:209], v[116:117] op_sel_hi:[1,0,1]
    v_pk_fma_f32 v[118:119], v[58:59], v[208:209], v[118:119] op_sel_hi:[1,0,1]
    v_pk_mul_f32 v[116:117], v[116:117], v[60:61]
    v_pk_mul_f32 v[118:119], v[118:119], v[62:63]
    v_cvt_pk_bf16_f32 v238, v116, v117
    v_cvt_pk_bf16_f32 v239, v118, v119
    ds_write_b128 v4, v[236:239] offset:0
    s_waitcnt lgkmcnt(11)
    v_pk_fma_f32 v[120:121], v[64:65], v[208:209], v[120:121] op_sel_hi:[1,0,1]
    v_pk_fma_f32 v[122:123], v[66:67], v[208:209], v[122:123] op_sel_hi:[1,0,1]
    v_pk_mul_f32 v[120:121], v[120:121], v[68:69]
    v_pk_mul_f32 v[122:123], v[122:123], v[70:71]
    v_cvt_pk_bf16_f32 v240, v120, v121
    v_cvt_pk_bf16_f32 v241, v122, v123
    s_waitcnt lgkmcnt(9)
    v_pk_fma_f32 v[124:125], v[72:73], v[208:209], v[124:125] op_sel_hi:[1,0,1]
    v_pk_fma_f32 v[126:127], v[74:75], v[208:209], v[126:127] op_sel_hi:[1,0,1]
    v_pk_mul_f32 v[124:125], v[124:125], v[76:77]
    v_pk_mul_f32 v[126:127], v[126:127], v[78:79]
    v_cvt_pk_bf16_f32 v242, v124, v125
    v_cvt_pk_bf16_f32 v243, v126, v127
    ds_write_b128 v4, v[240:243] offset:1024
    s_waitcnt lgkmcnt(8)
    v_pk_fma_f32 v[128:129], v[80:81], v[208:209], v[128:129] op_sel_hi:[1,0,1]
    v_pk_fma_f32 v[130:131], v[82:83], v[208:209], v[130:131] op_sel_hi:[1,0,1]
    v_pk_mul_f32 v[128:129], v[128:129], v[84:85]
    v_pk_mul_f32 v[130:131], v[130:131], v[86:87]
    v_cvt_pk_bf16_f32 v244, v128, v129
    v_cvt_pk_bf16_f32 v245, v130, v131
    s_waitcnt lgkmcnt(6)
    v_pk_fma_f32 v[132:133], v[88:89], v[208:209], v[132:133] op_sel_hi:[1,0,1]
    v_pk_fma_f32 v[134:135], v[90:91], v[208:209], v[134:135] op_sel_hi:[1,0,1]
    v_pk_mul_f32 v[132:133], v[132:133], v[92:93]
    v_pk_mul_f32 v[134:135], v[134:135], v[94:95]
    v_cvt_pk_bf16_f32 v246, v132, v133
    v_cvt_pk_bf16_f32 v247, v134, v135
    ds_write_b128 v4, v[244:247] offset:2048
    s_waitcnt lgkmcnt(5)
    v_pk_fma_f32 v[136:137], v[96:97], v[208:209], v[136:137] op_sel_hi:[1,0,1]
    v_pk_fma_f32 v[138:139], v[98:99], v[208:209], v[138:139] op_sel_hi:[1,0,1]
    v_pk_mul_f32 v[136:137], v[136:137], v[100:101]
    v_pk_mul_f32 v[138:139], v[138:139], v[102:103]
    v_cvt_pk_bf16_f32 v248, v136, v137
    v_cvt_pk_bf16_f32 v249, v138, v139
    s_waitcnt lgkmcnt(3)
    v_pk_fma_f32 v[140:141], v[104:105], v[208:209], v[140:141] op_sel_hi:[1,0,1]
    v_pk_fma_f32 v[142:143], v[106:107], v[208:209], v[142:143] op_sel_hi:[1,0,1]
    v_pk_mul_f32 v[140:141], v[140:141], v[108:109]
    v_pk_mul_f32 v[142:143], v[142:143], v[110:111]
    v_cvt_pk_bf16_f32 v250, v140, v141
    v_cvt_pk_bf16_f32 v251, v142, v143
    ds_write_b128 v4, v[248:251] offset:3072
    v_cvt_pk_bf16_f32 v228, v144, v145
    v_cvt_pk_bf16_f32 v229, v146, v147
    v_cvt_pk_bf16_f32 v230, v148, v149
    v_cvt_pk_bf16_f32 v231, v150, v151
    v_mfma_f32_16x16x16_bf16 v[144:147], v[224:225], v[228:229], 0
    v_cvt_pk_bf16_f32 v232, v152, v153
    v_cvt_pk_bf16_f32 v233, v154, v155
    v_mfma_f32_16x16x16_bf16 v[148:151], v[224:225], v[230:231], 0
    v_cvt_pk_bf16_f32 v234, v156, v157
    v_cvt_pk_bf16_f32 v235, v158, v159
    v_mfma_f32_16x16x16_bf16 v[152:155], v[224:225], v[232:233], 0
    s_nop 1
    ds_write_b128 v6, v[144:147] offset:49152
    v_cvt_pk_bf16_f32 v228, v160, v161
    v_cvt_pk_bf16_f32 v229, v162, v163
    v_mfma_f32_16x16x16_bf16 v[156:159], v[224:225], v[234:235], 0
    ds_write_b128 v6, v[148:151] offset:50176
    v_cvt_pk_bf16_f32 v230, v164, v165
    v_cvt_pk_bf16_f32 v231, v166, v167
    v_mfma_f32_16x16x16_bf16 v[160:163], v[224:225], v[228:229], 0
    ds_write_b128 v6, v[152:155] offset:51200
    v_cvt_pk_bf16_f32 v232, v168, v169
    v_cvt_pk_bf16_f32 v233, v170, v171
    v_mfma_f32_16x16x16_bf16 v[164:167], v[224:225], v[230:231], 0
    ds_write_b128 v6, v[156:159] offset:52224
    v_cvt_pk_bf16_f32 v234, v172, v173
    v_cvt_pk_bf16_f32 v235, v174, v175
    v_mfma_f32_16x16x16_bf16 v[168:171], v[224:225], v[232:233], 0
    ds_write_b128 v6, v[160:163] offset:53248
    v_mfma_f32_16x16x16_bf16 v[172:175], v[224:225], v[234:235], 0
    s_nop 1
    ds_write_b128 v6, v[164:167] offset:54272
    s_nop 2
    ds_write_b128 v6, v[168:171] offset:55296
    s_nop 0
    ds_write_b128 v6, v[172:175] offset:56320
    v_mov_b32 v231, s62
    v_and_b32 v1, 15, v0
    v_lshrrev_b32 v2, 4, v0
    v_lshlrev_b32 v2, 2, v2
    v_sub_u32 v1, v1, v2
    v_mov_b32 v2, 0x3f80
    v_mov_b32 v4, 0x3f800000
    v_cmp_eq_u32 vcc, 0, v1
    s_nop 1
    v_cndmask_b32 v16, 0, v2, vcc
    v_cmp_eq_u32 vcc, 1, v1
    s_nop 1
    v_cndmask_b32 v16, v16, v4, vcc
    v_cmp_eq_u32 vcc, 2, v1
    s_nop 1
    v_cndmask_b32 v17, 0, v2, vcc
    v_cmp_eq_u32 vcc, 3, v1
    s_nop 1
    v_cndmask_b32 v17, v17, v4, vcc
    v_mov_b32 v18, 0x3e800000
    v_and_b32 v1, 7, v0
    v_lshlrev_b32 v1, 10, v1
    v_add_u32 v1, 1020, v1
    s_waitcnt lgkmcnt(0)
    s_barrier
    s_setprio 3
    ds_read_b64_tr_b16 v[80:81], v9 offset:0
    ds_read_b64_tr_b16 v[82:83], v9 offset:1024
    ds_read_b64_tr_b16 v[84:85], v9 offset:2048
    ds_read_b64_tr_b16 v[86:87], v9 offset:3072
    ds_read_b64_tr_b16 v[88:89], v9 offset:4096
    ds_read_b64_tr_b16 v[90:91], v9 offset:5120
    ds_read_b64_tr_b16 v[92:93], v9 offset:6144
    ds_read_b64_tr_b16 v[94:95], v9 offset:7168
    ds_read_b128 v[48:51], v5 offset:0
    ds_read_b64_tr_b16 v[96:97], v10 offset:0
    ds_read_b64_tr_b16 v[98:99], v10 offset:1024
    ds_read_b128 v[52:55], v5 offset:1024
    ds_read_b64_tr_b16 v[100:101], v10 offset:2048
    ds_read_b64_tr_b16 v[102:103], v10 offset:3072
    ds_read_b128 v[56:59], v5 offset:2048
    ds_read_b64_tr_b16 v[104:105], v10 offset:4096
    ds_read_b64_tr_b16 v[106:107], v10 offset:5120
    ds_read_b128 v[60:63], v5 offset:3072
    ds_read_b64_tr_b16 v[108:109], v10 offset:6144
    ds_read_b64_tr_b16 v[110:111], v10 offset:7168
    s_waitcnt lgkmcnt(14)
    v_mfma_f32_16x16x32_bf16 v[20:23], v[80:83], v[236:239], 0
    v_mfma_f32_16x16x32_bf16 v[24:27], v[220:223], v[80:83], 0
    v_mfma_f32_16x16x32_bf16 v[20:23], v[84:87], v[240:243], v[20:23]
    v_mfma_f32_16x16x32_bf16 v[24:27], v[220:223], v[84:87], v[24:27]
    v_mfma_f32_16x16x32_bf16 v[20:23], v[88:91], v[244:247], v[20:23]
    v_mfma_f32_16x16x32_bf16 v[24:27], v[220:223], v[88:91], v[24:27]
    s_waitcnt lgkmcnt(12)
    v_mfma_f32_16x16x32_bf16 v[20:23], v[92:95], v[248:251], v[20:23]
    v_mfma_f32_16x16x32_bf16 v[24:27], v[220:223], v[92:95], v[24:27]
    s_waitcnt lgkmcnt(9)
    v_mfma_f32_16x16x32_bf16 v[20:23], v[96:99], v[48:51], v[20:23]
    v_mfma_f32_16x16x32_bf16 v[24:27], v[220:223], v[96:99], v[24:27]
    s_waitcnt lgkmcnt(6)
    v_mfma_f32_16x16x32_bf16 v[20:23], v[100:103], v[52:55], v[20:23]
    v_mfma_f32_16x16x32_bf16 v[24:27], v[220:223], v[100:103], v[24:27]
    s_waitcnt lgkmcnt(3)
    v_mfma_f32_16x16x32_bf16 v[20:23], v[104:107], v[56:59], v[20:23]
    v_mfma_f32_16x16x32_bf16 v[24:27], v[220:223], v[104:107], v[24:27]
    s_waitcnt lgkmcnt(0)
    v_mfma_f32_16x16x32_bf16 v[20:23], v[108:111], v[60:63], v[20:23]
    v_mfma_f32_16x16x32_bf16 v[24:27], v[220:223], v[108:111], v[24:27]
    s_nop 6
    v_cvt_pk_bf16_f32 v228, v20, v21
    v_cvt_pk_bf16_f32 v229, v22, v23
    v_mov_b32 v230, v24
    buffer_store_dwordx4 v[228:231], v3, s[40:43], s14 offen sc1
    s_add_u32 s15, s13, 4096
    buffer_load_dwordx4 v[80:83], v3, s[40:43], s13 offen offset:0 sc1
    buffer_load_dwordx4 v[84:87], v3, s[40:43], s13 offen offset:1024 sc1
    buffer_load_dwordx4 v[88:91], v3, s[40:43], s13 offen offset:2048 sc1
    buffer_load_dwordx4 v[92:95], v3, s[40:43], s13 offen offset:3072 sc1
    buffer_load_dwordx4 v[96:99], v3, s[40:43], s15 offen offset:0 sc1
    buffer_load_dwordx4 v[100:103], v3, s[40:43], s15 offen offset:1024 sc1
    buffer_load_dwordx4 v[104:107], v3, s[40:43], s15 offen offset:2048 sc1
    buffer_load_dwordx4 v[108:111], v3, s[40:43], s15 offen offset:3072 sc1
    s_lshl_b32 s21, s60, 12
    s_add_u32 s21, s21, 94208
    v_lshrrev_b32 v12, 3, v0
    v_lshlrev_b32 v8, 10, v12
    v_and_b32 v12, 7, v0
    v_lshrrev_b32 v13, 4, v0
    v_lshlrev_b32 v13, 1, v13
    v_xor_b32 v12, v12, v13
    v_lshl_or_b32 v8, v12, 4, v8
    s_lshl_b32 s64, s59, 7
    v_add_u32 v8, s64, v8
    v_add_u32 v9, 7168, v8
    v_add_u32 v10, 14336, v8
    v_add_u32 v11, 21504, v8
    v_lshrrev_b32 v13, 2, v0
    v_lshlrev_b32 v12, 7, v13
    v_bfe_u32 v13, v0, 3, 2
    v_lshl_or_b32 v12, v13, 5, v12
    v_and_b32 v13, 3, v0
    v_lshl_or_b32 v12, v13, 3, v12
    v_add_u32 v12, s21, v12
    v_xor_b32 v13, 32, v12
    v_xor_b32 v14, 64, v12
    v_xor_b32 v15, 96, v12
    s_lshl_b32 s23, s60, 2
    s_mov_b32 s70, 40000
    v_mov_b32 v4, 0
CW_42:
    ds_read_b32 v5, v4 offset:28
    s_waitcnt lgkmcnt(0)
    v_readfirstlane_b32 s71, v5
    s_nop 0
    s_cmp_ge_u32 s71, 4
    s_cbranch_scc1 CWD_43
    s_sub_u32 s70, s70, 1
    s_cbranch_scc1 CWD_43
    s_sleep 1
    s_branch CW_42
CWD_43:
    ds_read_b64_tr_b16 v[128:129], v12 offset:0
    ds_read_b64_tr_b16 v[130:131], v12 offset:2048
    ds_read_b64_tr_b16 v[132:133], v13 offset:0
    ds_read_b64_tr_b16 v[134:135], v13 offset:2048
    ds_read_b64_tr_b16 v[136:137], v14 offset:0
    ds_read_b64_tr_b16 v[138:139], v14 offset:2048
    ds_read_b64_tr_b16 v[140:141], v15 offset:0
    ds_read_b64_tr_b16 v[142:143], v15 offset:2048
    ds_read_b64_tr_b16 v[144:145], v12 offset:16384
    ds_read_b64_tr_b16 v[146:147], v12 offset:18432
    ds_read_b64_tr_b16 v[148:149], v13 offset:16384
    ds_read_b64_tr_b16 v[150:151], v13 offset:18432
    ds_read_b64_tr_b16 v[152:153], v14 offset:16384
    ds_read_b64_tr_b16 v[154:155], v14 offset:18432
    ds_read_b64_tr_b16 v[156:157], v15 offset:16384
    ds_read_b64_tr_b16 v[158:159], v15 offset:18432
    ds_read_b64_tr_b16 v[160:161], v12 offset:32768
    ds_read_b64_tr_b16 v[162:163], v12 offset:34816
    ds_read_b64_tr_b16 v[164:165], v13 offset:32768
    ds_read_b64_tr_b16 v[166:167], v13 offset:34816
    ds_read_b64_tr_b16 v[168:169], v14 offset:32768
    ds_read_b64_tr_b16 v[170:171], v14 offset:34816
    ds_read_b64_tr_b16 v[172:173], v15 offset:32768
    ds_read_b64_tr_b16 v[174:175], v15 offset:34816
    ds_read_b64_tr_b16 v[176:177], v12 offset:49152
    ds_read_b64_tr_b16 v[178:179], v12 offset:51200
    ds_read_b64_tr_b16 v[180:181], v13 offset:49152
    ds_read_b64_tr_b16 v[182:183], v13 offset:51200
    ds_read_b64_tr_b16 v[184:185], v14 offset:49152
    ds_read_b64_tr_b16 v[186:187], v14 offset:51200
    ds_read_b64_tr_b16 v[188:189], v15 offset:49152
    ds_read_b64_tr_b16 v[190:191], v15 offset:51200
    s_lshl_b32 s65, s60, 2
    s_waitcnt lgkmcnt(0)
    v_mov_b32 v4, s65
    v_mov_b32 v5, 1
    s_mov_b64 exec, 1
    ds_add_u32 v4, v5 offset:32
    s_mov_b64 exec, -1
    s_sub_u32 s21, s21, 90112
    s_mov_b32 s70, 40000
    s_branch G2_41
GG_39:
    s_bitcmp0_b32 s66, 7
    s_cbranch_scc1 GS_44
    buffer_load_dwordx4 v[80:83], v3, s[40:43], s13 offen offset:0 sc1
GS_44:
    s_bitcmp0_b32 s66, 6
    s_cbranch_scc1 GS_45
    buffer_load_dwordx4 v[84:87], v3, s[40:43], s13 offen offset:1024 sc1
GS_45:
    s_bitcmp0_b32 s66, 5
    s_cbranch_scc1 GS_46
    buffer_load_dwordx4 v[88:91], v3, s[40:43], s13 offen offset:2048 sc1
GS_46:
    s_bitcmp0_b32 s66, 4
    s_cbranch_scc1 GS_47
    buffer_load_dwordx4 v[92:95], v3, s[40:43], s13 offen offset:3072 sc1
GS_47:
    s_bitcmp0_b32 s66, 3
    s_cbranch_scc1 GS_48
    buffer_load_dwordx4 v[96:99], v3, s[40:43], s15 offen offset:0 sc1
GS_48:
    s_bitcmp0_b32 s66, 2
    s_cbranch_scc1 GS_49
    buffer_load_dwordx4 v[100:103], v3, s[40:43], s15 offen offset:1024 sc1
GS_49:
    s_bitcmp0_b32 s66, 1
    s_cbranch_scc1 GS_50
    buffer_load_dwordx4 v[104:107], v3, s[40:43], s15 offen offset:2048 sc1
GS_50:
    s_bitcmp0_b32 s66, 0
    s_cbranch_scc1 GS_51
    buffer_load_dwordx4 v[108:111], v3, s[40:43], s15 offen offset:3072 sc1
GS_51:
G2_41:
    s_mov_b32 s66, 0
    s_waitcnt vmcnt(0)
    v_cmp_eq_u32 vcc, s62, v83
    s_nop 0
    s_cmp_lg_u64 vcc, -1
    s_addc_u32 s66, s66, s66
    v_cmp_eq_u32 vcc, s62, v87
    s_nop 0
    s_cmp_lg_u64 vcc, -1
    s_addc_u32 s66, s66, s66
    v_cmp_eq_u32 vcc, s62, v91
    s_nop 0
    s_cmp_lg_u64 vcc, -1
    s_addc_u32 s66, s66, s66
    v_cmp_eq_u32 vcc, s62, v95
    s_nop 0
    s_cmp_lg_u64 vcc, -1
    s_addc_u32 s66, s66, s66
    v_cmp_eq_u32 vcc, s62, v99
    s_nop 0
    s_cmp_lg_u64 vcc, -1
    s_addc_u32 s66, s66, s66
    v_cmp_eq_u32 vcc, s62, v103
    s_nop 0
    s_cmp_lg_u64 vcc, -1
    s_addc_u32 s66, s66, s66
    v_cmp_eq_u32 vcc, s62, v107
    s_nop 0
    s_cmp_lg_u64 vcc, -1
    s_addc_u32 s66, s66, s66
    v_cmp_eq_u32 vcc, s62, v111
    s_nop 0
    s_cmp_lg_u64 vcc, -1
    s_addc_u32 s66, s66, s66
    s_cmp_eq_u32 s66, 0
    s_cbranch_scc1 GDD_40
    s_sub_u32 s70, s70, 1
    s_cbranch_scc0 GG_39
GDD_40:
    v_mfma_f32_16x16x16_bf16 v[20:23], v[16:17], v[80:81], 0
    v_mfma_f32_16x16x16_bf16 v[20:23], v[16:17], v[84:85], v[20:23]
    v_add_f32 v28, v82, v86
    v_mfma_f32_16x16x16_bf16 v[20:23], v[16:17], v[88:89], v[20:23]
    v_add_f32 v28, v28, v90
    v_mfma_f32_16x16x16_bf16 v[20:23], v[16:17], v[92:93], v[20:23]
    v_add_f32 v28, v28, v94
    v_mfma_f32_16x16x16_bf16 v[20:23], v[16:17], v[96:97], v[20:23]
    v_add_f32 v28, v28, v98
    v_mfma_f32_16x16x16_bf16 v[20:23], v[16:17], v[100:101], v[20:23]
    v_add_f32 v28, v28, v102
    v_mfma_f32_16x16x16_bf16 v[20:23], v[16:17], v[104:105], v[20:23]
    v_add_f32 v28, v28, v106
    v_mfma_f32_16x16x16_bf16 v[20:23], v[16:17], v[108:109], v[20:23]
    v_add_f32 v28, v28, v110
    s_nop 1
    v_mfma_f32_16x16x4_f32 v[24:27], v28, v18, 0
    s_nop 3
    v_cvt_pk_bf16_f32 v228, v20, v21
    v_cvt_pk_bf16_f32 v229, v22, v23
    s_nop 5
    v_cvt_pk_bf16_f32 v230, v24, v25
    v_cvt_pk_bf16_f32 v231, v26, v27
    s_lshl_b32 s64, s60, 10
    s_add_u32 s64, s64, 86016
    v_add_u32 v4, s64, v3
    ds_write_b128 v4, v[228:231]
    s_waitcnt lgkmcnt(0)
    s_lshl_b32 s65, s16, 3
    v_mov_b32 v4, s65
    v_mov_b32 v5, 2
    s_mov_b64 exec, 1
    ds_add_u32 v4, v5 offset:132
    s_mov_b64 exec, -1
    v_mov_b32 v7, v3
    s_mov_b32 s70, 40000
    v_mov_b32 v20, s65
CW_52:
    ds_read_b64 v[22:23], v20 offset:128
    s_waitcnt lgkmcnt(0)
    v_min_u32 v21, v22, v23
    s_nop 0
    v_readfirstlane_b32 s71, v21
    s_nop 0
    s_cmp_ge_u32 s71, 4
    s_cbranch_scc1 CWD_53
    s_sub_u32 s70, s70, 1
    s_cbranch_scc1 CWD_53
    s_sleep 1
    s_branch CW_52
CWD_53:
    s_lshl_b32 s64, s16, 10
    s_add_u32 s64, s64, 86016
    v_add_u32 v4, s64, v3
    ds_read_b64 v[84:85], v4
    ds_read_b64 v[86:87], v4 offset:2048
    ds_read_b64 v[80:81], v4 offset:8
    ds_read_b64 v[82:83], v4 offset:2056
    ds_read_b128 v[48:51], v6 offset:49152
    ds_read_b128 v[52:55], v6 offset:50176
    ds_read_b128 v[56:59], v6 offset:51200
    ds_read_b128 v[60:63], v6 offset:52224
    ds_read_b128 v[64:67], v6 offset:53248
    ds_read_b128 v[68:71], v6 offset:54272
    ds_read_b128 v[72:75], v6 offset:55296
    ds_read_b128 v[76:79], v6 offset:56320
    s_mul_i32 s64, s16, 73720
    s_add_u32 s19, s19, s64
    s_waitcnt lgkmcnt(7)
    v_mfma_f32_16x16x32_bf16 v[16:19], v[84:87], v[48:51], 0
    v_mfma_f32_16x16x32_bf16 v[96:99], v[80:83], v[48:51], 0
    s_waitcnt lgkmcnt(6)
    v_mfma_f32_16x16x32_bf16 v[20:23], v[84:87], v[52:55], 0
    v_mfma_f32_16x16x32_bf16 v[100:103], v[80:83], v[52:55], 0
    s_waitcnt lgkmcnt(5)
    v_mfma_f32_16x16x32_bf16 v[24:27], v[84:87], v[56:59], 0
    v_mfma_f32_16x16x32_bf16 v[104:107], v[80:83], v[56:59], 0
    s_nop 1
    v_add_f32 v96, 0x358637bd, v96
    v_rcp_f32 v96, v96
    s_nop 0
    v_pk_mul_f32 v[16:17], v[16:17], v[96:97] op_sel_hi:[1,0]
    v_pk_mul_f32 v[18:19], v[18:19], v[96:97] op_sel_hi:[1,0]
    v_cvt_pk_bf16_f32 v16, v16, v17
    v_cvt_pk_bf16_f32 v17, v18, v19
    s_waitcnt lgkmcnt(4)
    v_mfma_f32_16x16x32_bf16 v[28:31], v[84:87], v[60:63], 0
    v_mfma_f32_16x16x32_bf16 v[108:111], v[80:83], v[60:63], 0
    v_add_f32 v100, 0x358637bd, v100
    v_rcp_f32 v100, v100
    s_nop 0
    v_pk_mul_f32 v[20:21], v[20:21], v[100:101] op_sel_hi:[1,0]
    v_pk_mul_f32 v[22:23], v[22:23], v[100:101] op_sel_hi:[1,0]
    v_cvt_pk_bf16_f32 v18, v20, v21
    v_cvt_pk_bf16_f32 v19, v22, v23
    s_add_u32 s64, s19, 0
    buffer_store_dwordx4 v[16:19], v7, s[40:43], s64 offen sc1
    s_waitcnt lgkmcnt(3)
    v_mfma_f32_16x16x32_bf16 v[32:35], v[84:87], v[64:67], 0
    v_mfma_f32_16x16x32_bf16 v[96:99], v[80:83], v[64:67], 0
    v_add_f32 v104, 0x358637bd, v104
    v_rcp_f32 v104, v104
    s_nop 0
    v_pk_mul_f32 v[24:25], v[24:25], v[104:105] op_sel_hi:[1,0]
    v_pk_mul_f32 v[26:27], v[26:27], v[104:105] op_sel_hi:[1,0]
    v_cvt_pk_bf16_f32 v24, v24, v25
    v_cvt_pk_bf16_f32 v25, v26, v27
    s_waitcnt lgkmcnt(2)
    v_mfma_f32_16x16x32_bf16 v[36:39], v[84:87], v[68:71], 0
    v_mfma_f32_16x16x32_bf16 v[100:103], v[80:83], v[68:71], 0
    v_add_f32 v108, 0x358637bd, v108
    v_rcp_f32 v108, v108
    s_nop 0
    v_pk_mul_f32 v[28:29], v[28:29], v[108:109] op_sel_hi:[1,0]
    v_pk_mul_f32 v[30:31], v[30:31], v[108:109] op_sel_hi:[1,0]
    v_cvt_pk_bf16_f32 v26, v28, v29
    v_cvt_pk_bf16_f32 v27, v30, v31
    s_add_u32 s64, s19, 147456
    buffer_store_dwordx4 v[24:27], v7, s[40:43], s64 offen sc1
    s_waitcnt lgkmcnt(1)
    v_mfma_f32_16x16x32_bf16 v[40:43], v[84:87], v[72:75], 0
    v_mfma_f32_16x16x32_bf16 v[104:107], v[80:83], v[72:75], 0
    v_add_f32 v96, 0x358637bd, v96
    v_rcp_f32 v96, v96
    s_nop 0
    v_pk_mul_f32 v[32:33], v[32:33], v[96:97] op_sel_hi:[1,0]
    v_pk_mul_f32 v[34:35], v[34:35], v[96:97] op_sel_hi:[1,0]
    v_cvt_pk_bf16_f32 v32, v32, v33
    v_cvt_pk_bf16_f32 v33, v34, v35
    s_waitcnt lgkmcnt(0)
    v_mfma_f32_16x16x32_bf16 v[44:47], v[84:87], v[76:79], 0
    v_mfma_f32_16x16x32_bf16 v[108:111], v[80:83], v[76:79], 0
    v_add_f32 v100, 0x358637bd, v100
    v_rcp_f32 v100, v100
    s_nop 0
    v_pk_mul_f32 v[36:37], v[36:37], v[100:101] op_sel_hi:[1,0]
    v_pk_mul_f32 v[38:39], v[38:39], v[100:101] op_sel_hi:[1,0]
    v_cvt_pk_bf16_f32 v34, v36, v37
    v_cvt_pk_bf16_f32 v35, v38, v39
    s_add_u32 s64, s19, 294912
    buffer_store_dwordx4 v[32:35], v7, s[40:43], s64 offen sc1
    v_add_f32 v104, 0x358637bd, v104
    v_rcp_f32 v104, v104
    s_nop 0
    v_pk_mul_f32 v[40:41], v[40:41], v[104:105] op_sel_hi:[1,0]
    v_pk_mul_f32 v[42:43], v[42:43], v[104:105] op_sel_hi:[1,0]
    v_cvt_pk_bf16_f32 v40, v40, v41
    v_cvt_pk_bf16_f32 v41, v42, v43
    v_add_f32 v108, 0x358637bd, v108
    v_rcp_f32 v108, v108
    s_nop 0
    v_pk_mul_f32 v[44:45], v[44:45], v[108:109] op_sel_hi:[1,0]
    v_pk_mul_f32 v[46:47], v[46:47], v[108:109] op_sel_hi:[1,0]
    v_cvt_pk_bf16_f32 v42, v44, v45
    v_cvt_pk_bf16_f32 v43, v46, v47
    s_add_u32 s64, s19, 442368
    buffer_store_dwordx4 v[40:43], v7, s[40:43], s64 offen sc1
    s_setprio 0
    v_lshlrev_b32 v3, 2, v0
    s_lshr_b32 s69, s58, 1
    s_lshl_b32 s69, s69, 8
    s_add_u32 s69, s69, 0x909000
    s_waitcnt vmcnt(0)
    v_mov_b32 v1, s62
    v_mov_b32 v2, 0
    s_mov_b64 exec, 1
    s_cmp_eq_u32 s63, 0
    s_cbranch_scc1 FS_54
    buffer_store_dword v1, v2, s[40:43], s18 offen
    s_branch FD_55
FS_54:
    buffer_wbl2 sc1
    s_waitcnt vmcnt(0)
    buffer_store_dword v1, v2, s[40:43], s18 offen sc1
FD_55:
    s_mov_b64 exec, -1
    v_mov_b32 v6, 0
    v_mov_b32 v7, 1
    s_mov_b64 exec, 1
    ds_add_u32 v6, v7 offset:8
    s_mov_b64 exec, -1
    s_mov_b32 s12, 0
L_P2C:
    buffer_load_dword v4, v3, s[40:43], s69 offen sc1
    v_lshlrev_b32 v1, 4, v0
    v_add_u32 v2, s21, v1
    s_mul_i32 s68, s58, 288
    s_add_u32 s68, s68, s23
    s_add_u32 s68, s68, 56
    s_lshl_b32 s68, s68, 10
    s_lshl_b32 s64, s60, 3
    s_lshl_b32 s67, 0xff, s64
    s_cmp_eq_u32 s12, 0
    s_cbranch_scc1 NX_56
    s_waitcnt vmcnt(1)
    v_mov_b32 v98, s62
    v_mov_b32 v99, 0
    s_mov_b64 exec, 1
    s_cmp_eq_u32 s63, 0
    s_cbranch_scc1 FS_57
    buffer_store_dword v98, v99, s[40:43], s13 offen
    s_branch FD_58
FS_57:
    buffer_wbl2 sc1
    s_waitcnt vmcnt(0)
    buffer_store_dword v98, v99, s[40:43], s13 offen sc1
FD_58:
    s_mov_b64 exec, -1
NX_56:
    s_mov_b32 s70, 40000
    s_waitcnt vmcnt(0)
    s_branch FPC_61
FP_59:
    buffer_load_dword v4, v3, s[40:43], s69 offen sc1
    s_waitcnt vmcnt(0)
FPC_61:
    v_cmp_eq_u32 vcc, s62, v4
    s_nop 0
    s_and_b32 s71, vcc_lo, s67
    s_cmp_eq_u32 s71, s67
    s_cbranch_scc1 FPD_60
    s_sub_u32 s70, s70, 1
    s_cbranch_scc1 FPD_60
    s_sleep 1
    s_branch FP_59
FPD_60:
    s_add_u32 s64, s68, 0
    buffer_load_dwordx4 v[16:19], v1, s[40:43], s64 offen offset:0 sc1
    s_add_u32 s64, s68, 73728
    buffer_load_dwordx4 v[32:35], v1, s[40:43], s64 offen offset:0 sc1
    s_add_u32 s64, s68, 0
    buffer_load_dwordx4 v[20:23], v1, s[40:43], s64 offen offset:1024 sc1
    s_add_u32 s64, s68, 73728
    buffer_load_dwordx4 v[36:39], v1, s[40:43], s64 offen offset:1024 sc1
    s_add_u32 s64, s68, 0
    buffer_load_dwordx4 v[24:27], v1, s[40:43], s64 offen offset:2048 sc1
    s_add_u32 s64, s68, 73728
    buffer_load_dwordx4 v[40:43], v1, s[40:43], s64 offen offset:2048 sc1
    s_add_u32 s64, s68, 0
    buffer_load_dwordx4 v[28:31], v1, s[40:43], s64 offen offset:3072 sc1
    s_add_u32 s64, s68, 73728
    buffer_load_dwordx4 v[44:47], v1, s[40:43], s64 offen offset:3072 sc1
    s_add_u32 s64, s68, 147456
    buffer_load_dwordx4 v[48:51], v1, s[40:43], s64 offen offset:0 sc1
    s_add_u32 s64, s68, 221184
    buffer_load_dwordx4 v[64:67], v1, s[40:43], s64 offen offset:0 sc1
    s_add_u32 s64, s68, 147456
    buffer_load_dwordx4 v[52:55], v1, s[40:43], s64 offen offset:1024 sc1
    s_add_u32 s64, s68, 221184
    buffer_load_dwordx4 v[68:71], v1, s[40:43], s64 offen offset:1024 sc1
    s_add_u32 s64, s68, 147456
    buffer_load_dwordx4 v[56:59], v1, s[40:43], s64 offen offset:2048 sc1
    s_add_u32 s64, s68, 221184
    buffer_load_dwordx4 v[72:75], v1, s[40:43], s64 offen offset:2048 sc1
    s_add_u32 s64, s68, 147456
    buffer_load_dwordx4 v[60:63], v1, s[40:43], s64 offen offset:3072 sc1
    s_add_u32 s64, s68, 221184
    buffer_load_dwordx4 v[76:79], v1, s[40:43], s64 offen offset:3072 sc1
    s_mov_b32 s70, 40000
    v_mov_b32 v98, 0
CW_62:
    ds_read_b32 v99, v98 offset:8
    s_waitcnt lgkmcnt(0)
    v_readfirstlane_b32 s71, v99
    s_nop 0
    s_cmp_ge_u32 s71, 4
    s_cbranch_scc1 CWD_63
    s_sub_u32 s70, s70, 1
    s_cbranch_scc1 CWD_63
    s_sleep 1
    s_branch CW_62
CWD_63:
    v_mov_b32 v98, 0
    v_mov_b32 v99, 2
    s_waitcnt vmcnt(14)
    v_swap_b32 v18, v32
    v_swap_b32 v19, v33
    s_nop 1
    v_mfma_f32_16x16x32_bf16 v[192:195], v[128:131], v[16:19], 0
    v_mfma_f32_16x16x32_bf16 v[196:199], v[132:135], v[16:19], 0
    v_mfma_f32_16x16x32_bf16 v[200:203], v[136:139], v[16:19], 0
    v_mfma_f32_16x16x32_bf16 v[204:207], v[140:143], v[16:19], 0
    v_mfma_f32_16x16x32_bf16 v[208:211], v[128:131], v[32:35], 0
    s_waitcnt vmcnt(12)
    v_swap_b32 v22, v36
    v_swap_b32 v23, v37
    v_mfma_f32_16x16x32_bf16 v[212:215], v[132:135], v[32:35], 0
    v_mfma_f32_16x16x32_bf16 v[216:219], v[136:139], v[32:35], 0
    v_mfma_f32_16x16x32_bf16 v[220:223], v[140:143], v[32:35], 0
    v_mfma_f32_16x16x32_bf16 v[192:195], v[144:147], v[20:23], v[192:195]
    v_mfma_f32_16x16x32_bf16 v[196:199], v[148:151], v[20:23], v[196:199]
    v_mfma_f32_16x16x32_bf16 v[200:203], v[152:155], v[20:23], v[200:203]
    v_mfma_f32_16x16x32_bf16 v[204:207], v[156:159], v[20:23], v[204:207]
    v_mfma_f32_16x16x32_bf16 v[208:211], v[144:147], v[36:39], v[208:211]
    s_waitcnt vmcnt(10)
    v_swap_b32 v26, v40
    v_swap_b32 v27, v41
    v_mfma_f32_16x16x32_bf16 v[212:215], v[148:151], v[36:39], v[212:215]
    v_mfma_f32_16x16x32_bf16 v[216:219], v[152:155], v[36:39], v[216:219]
    v_mfma_f32_16x16x32_bf16 v[220:223], v[156:159], v[36:39], v[220:223]
    v_mfma_f32_16x16x32_bf16 v[192:195], v[160:163], v[24:27], v[192:195]
    v_mfma_f32_16x16x32_bf16 v[196:199], v[164:167], v[24:27], v[196:199]
    v_mfma_f32_16x16x32_bf16 v[200:203], v[168:171], v[24:27], v[200:203]
    v_mfma_f32_16x16x32_bf16 v[204:207], v[172:175], v[24:27], v[204:207]
    v_mfma_f32_16x16x32_bf16 v[208:211], v[160:163], v[40:43], v[208:211]
    s_waitcnt vmcnt(8)
    v_swap_b32 v30, v44
    v_swap_b32 v31, v45
    v_mfma_f32_16x16x32_bf16 v[212:215], v[164:167], v[40:43], v[212:215]
    v_mfma_f32_16x16x32_bf16 v[216:219], v[168:171], v[40:43], v[216:219]
    v_mfma_f32_16x16x32_bf16 v[220:223], v[172:175], v[40:43], v[220:223]
    v_mfma_f32_16x16x32_bf16 v[192:195], v[176:179], v[28:31], v[192:195]
    v_mfma_f32_16x16x32_bf16 v[196:199], v[180:183], v[28:31], v[196:199]
    v_mfma_f32_16x16x32_bf16 v[200:203], v[184:187], v[28:31], v[200:203]
    v_mfma_f32_16x16x32_bf16 v[204:207], v[188:191], v[28:31], v[204:207]
    v_mfma_f32_16x16x32_bf16 v[208:211], v[176:179], v[44:47], v[208:211]
    s_waitcnt vmcnt(6)
    v_swap_b32 v50, v64
    v_swap_b32 v51, v65
    v_mfma_f32_16x16x32_bf16 v[212:215], v[180:183], v[44:47], v[212:215]
    v_mfma_f32_16x16x32_bf16 v[216:219], v[184:187], v[44:47], v[216:219]
    v_mfma_f32_16x16x32_bf16 v[220:223], v[188:191], v[44:47], v[220:223]
    v_mfma_f32_16x16x32_bf16 v[224:227], v[128:131], v[48:51], 0
    s_waitcnt vmcnt(4)
    v_swap_b32 v54, v68
    v_swap_b32 v55, v69
    v_mfma_f32_16x16x32_bf16 v[228:231], v[132:135], v[48:51], 0
    v_mfma_f32_16x16x32_bf16 v[232:235], v[136:139], v[48:51], 0
    ds_write_b128 v2, v[192:195] offset:0
    v_mfma_f32_16x16x32_bf16 v[236:239], v[140:143], v[48:51], 0
    ds_write_b128 v2, v[196:199] offset:1024
    v_mfma_f32_16x16x32_bf16 v[224:227], v[144:147], v[52:55], v[224:227]
    s_waitcnt vmcnt(2)
    v_swap_b32 v58, v72
    v_swap_b32 v59, v73
    v_mfma_f32_16x16x32_bf16 v[228:231], v[148:151], v[52:55], v[228:231]
    v_mfma_f32_16x16x32_bf16 v[232:235], v[152:155], v[52:55], v[232:235]
    ds_write_b128 v2, v[200:203] offset:2048
    v_mfma_f32_16x16x32_bf16 v[236:239], v[156:159], v[52:55], v[236:239]
    ds_write_b128 v2, v[204:207] offset:3072
    v_mfma_f32_16x16x32_bf16 v[224:227], v[160:163], v[56:59], v[224:227]
    s_waitcnt vmcnt(0)
    v_swap_b32 v62, v76
    v_swap_b32 v63, v77
    v_mfma_f32_16x16x32_bf16 v[228:231], v[164:167], v[56:59], v[228:231]
    v_mfma_f32_16x16x32_bf16 v[232:235], v[168:171], v[56:59], v[232:235]
    ds_write_b128 v2, v[208:211] offset:16384
    v_mfma_f32_16x16x32_bf16 v[236:239], v[172:175], v[56:59], v[236:239]
    ds_write_b128 v2, v[212:215] offset:17408
    v_mfma_f32_16x16x32_bf16 v[224:227], v[176:179], v[60:63], v[224:227]
    v_mfma_f32_16x16x32_bf16 v[228:231], v[180:183], v[60:63], v[228:231]
    v_mfma_f32_16x16x32_bf16 v[232:235], v[184:187], v[60:63], v[232:235]
    ds_write_b128 v2, v[216:219] offset:18432
    v_mfma_f32_16x16x32_bf16 v[236:239], v[188:191], v[60:63], v[236:239]
    ds_write_b128 v2, v[220:223] offset:19456
    v_mfma_f32_16x16x32_bf16 v[240:243], v[128:131], v[64:67], 0
    v_mfma_f32_16x16x32_bf16 v[244:247], v[132:135], v[64:67], 0
    v_mfma_f32_16x16x32_bf16 v[248:251], v[136:139], v[64:67], 0
    v_mfma_f32_16x16x32_bf16 v[252:255], v[140:143], v[64:67], 0
    s_waitcnt lgkmcnt(0)
    s_mov_b64 exec, 1
    ds_add_u32 v98, v99 offset:32
    ds_add_u32 v98, v99 offset:36
    s_mov_b64 exec, -1
    v_mfma_f32_16x16x32_bf16 v[240:243], v[144:147], v[68:71], v[240:243]
    ds_write_b128 v2, v[224:227] offset:32768
    v_mfma_f32_16x16x32_bf16 v[244:247], v[148:151], v[68:71], v[244:247]
    ds_write_b128 v2, v[228:231] offset:33792
    v_mfma_f32_16x16x32_bf16 v[248:251], v[152:155], v[68:71], v[248:251]
    ds_write_b128 v2, v[232:235] offset:34816
    v_mfma_f32_16x16x32_bf16 v[252:255], v[156:159], v[68:71], v[252:255]
    ds_write_b128 v2, v[236:239] offset:35840
    v_mfma_f32_16x16x32_bf16 v[240:243], v[160:163], v[72:75], v[240:243]
    v_mfma_f32_16x16x32_bf16 v[244:247], v[164:167], v[72:75], v[244:247]
    v_mfma_f32_16x16x32_bf16 v[248:251], v[168:171], v[72:75], v[248:251]
    v_mfma_f32_16x16x32_bf16 v[252:255], v[172:175], v[72:75], v[252:255]
    v_mfma_f32_16x16x32_bf16 v[240:243], v[176:179], v[76:79], v[240:243]
    s_waitcnt lgkmcnt(0)
    s_mov_b64 exec, 1
    ds_add_u32 v98, v99 offset:40
    s_mov_b64 exec, -1
    v_mfma_f32_16x16x32_bf16 v[244:247], v[180:183], v[76:79], v[244:247]
    v_mfma_f32_16x16x32_bf16 v[248:251], v[184:187], v[76:79], v[248:251]
    v_mfma_f32_16x16x32_bf16 v[252:255], v[188:191], v[76:79], v[252:255]
    s_nop 0
    ds_write_b128 v2, v[240:243] offset:49152
    s_nop 3
    ds_write_b128 v2, v[244:247] offset:50176
    ds_write_b128 v2, v[248:251] offset:51200
    ds_write_b128 v2, v[252:255] offset:52224
    s_waitcnt lgkmcnt(0)
    s_mov_b64 exec, 1
    ds_add_u32 v98, v99 offset:44
    s_mov_b64 exec, -1
    s_endpgm
L_FINL:
    buffer_load_dwordx4 v[120:123], v5, s[24:27], 0 offen
    buffer_load_dwordx4 v[124:127], v5, s[24:27], 0 offen offset:64
    s_lshl_b32 s64, s60, 14
    v_add_u32 v1, s64, v6
    v_add_u32 v2, 94208, v1
    v_and_b32 v4, 15, v0
    v_lshlrev_b32 v4, 2, v4
    s_and_b32 s64, s58, 3
    s_lshl_b32 s64, s64, 8
    s_lshl_b32 s65, s60, 6
    s_add_u32 s64, s64, s65
    v_add_u32 v4, s64, v4
    ds_read_b32 v4, v4 offset:2048
    s_lshl_b32 s65, s60, 2
    s_mov_b32 s70, 40000
    v_mov_b32 v98, s65
CW_64:
    ds_read_b32 v99, v98 offset:48
    s_waitcnt lgkmcnt(0)
    v_readfirstlane_b32 s71, v99
    s_nop 0
    s_cmp_ge_u32 s71, 8
    s_cbranch_scc1 CWD_65
    s_sub_u32 s70, s70, 1
    s_cbranch_scc1 CWD_65
    s_sleep 1
    s_branch CW_64
CWD_65:
    ds_read_b128 v[32:35], v2 offset:0
    ds_read_b128 v[36:39], v2 offset:256
    ds_read_b128 v[40:43], v2 offset:2048
    ds_read_b128 v[44:47], v2 offset:2304
    ds_read_b128 v[48:51], v2 offset:4096
    ds_read_b128 v[52:55], v2 offset:4352
    ds_read_b128 v[56:59], v2 offset:6144
    ds_read_b128 v[60:63], v2 offset:6400
    ds_read_b128 v[64:67], v2 offset:8192
    ds_read_b128 v[68:71], v2 offset:8448
    ds_read_b128 v[72:75], v2 offset:10240
    ds_read_b128 v[76:79], v2 offset:10496
    ds_read_b128 v[80:83], v2 offset:12288
    ds_read_b128 v[84:87], v2 offset:12544
    ds_read_b128 v[88:91], v2 offset:14336
    ds_read_b128 v[92:95], v2 offset:14592
    s_waitcnt lgkmcnt(11)
    v_pk_add_f32 v[16:17], v[32:33], v[48:49]
    v_pk_add_f32 v[18:19], v[34:35], v[50:51]
    s_waitcnt lgkmcnt(10)
    v_pk_add_f32 v[20:21], v[36:37], v[52:53]
    v_pk_add_f32 v[22:23], v[38:39], v[54:55]
    s_waitcnt lgkmcnt(9)
    v_pk_add_f32 v[24:25], v[40:41], v[56:57]
    v_pk_add_f32 v[26:27], v[42:43], v[58:59]
    s_waitcnt lgkmcnt(8)
    v_pk_add_f32 v[28:29], v[44:45], v[60:61]
    v_pk_add_f32 v[30:31], v[46:47], v[62:63]
    s_waitcnt lgkmcnt(7)
    v_pk_add_f32 v[16:17], v[16:17], v[64:65]
    v_pk_add_f32 v[18:19], v[18:19], v[66:67]
    s_waitcnt lgkmcnt(6)
    v_pk_add_f32 v[20:21], v[20:21], v[68:69]
    v_pk_add_f32 v[22:23], v[22:23], v[70:71]
    s_waitcnt lgkmcnt(5)
    v_pk_add_f32 v[24:25], v[24:25], v[72:73]
    v_pk_add_f32 v[26:27], v[26:27], v[74:75]
    s_waitcnt lgkmcnt(4)
    v_pk_add_f32 v[28:29], v[28:29], v[76:77]
    v_pk_add_f32 v[30:31], v[30:31], v[78:79]
    s_waitcnt lgkmcnt(3)
    v_pk_add_f32 v[16:17], v[16:17], v[80:81]
    v_pk_add_f32 v[18:19], v[18:19], v[82:83]
    s_waitcnt lgkmcnt(2)
    v_pk_add_f32 v[20:21], v[20:21], v[84:85]
    v_pk_add_f32 v[22:23], v[22:23], v[86:87]
    s_waitcnt lgkmcnt(1)
    v_pk_add_f32 v[24:25], v[24:25], v[88:89]
    v_pk_add_f32 v[26:27], v[26:27], v[90:91]
    s_waitcnt lgkmcnt(0)
    v_pk_add_f32 v[28:29], v[28:29], v[92:93]
    v_pk_add_f32 v[30:31], v[30:31], v[94:95]
    s_waitcnt vmcnt(0)
    v_pk_add_f32 v[16:17], v[16:17], v[104:105]
    v_pk_add_f32 v[18:19], v[18:19], v[106:107]
    v_pk_add_f32 v[20:21], v[20:21], v[108:109]
    v_pk_add_f32 v[22:23], v[22:23], v[110:111]
    v_pk_add_f32 v[24:25], v[24:25], v[112:113]
    v_pk_add_f32 v[26:27], v[26:27], v[114:115]
    v_pk_add_f32 v[28:29], v[28:29], v[116:117]
    v_pk_add_f32 v[30:31], v[30:31], v[118:119]
    v_lshlrev_b32 v32, 16, v120
    v_and_b32 v33, 0xffff0000, v120
    v_lshlrev_b32 v34, 16, v121
    v_and_b32 v35, 0xffff0000, v121
    v_lshlrev_b32 v36, 16, v122
    v_and_b32 v37, 0xffff0000, v122
    v_lshlrev_b32 v38, 16, v123
    v_and_b32 v39, 0xffff0000, v123
    v_lshlrev_b32 v40, 16, v124
    v_and_b32 v41, 0xffff0000, v124
    v_lshlrev_b32 v42, 16, v125
    v_and_b32 v43, 0xffff0000, v125
    v_lshlrev_b32 v44, 16, v126
    v_and_b32 v45, 0xffff0000, v126
    v_lshlrev_b32 v46, 16, v127
    v_and_b32 v47, 0xffff0000, v127
    v_pk_fma_f32 v[16:17], v[16:17], v[4:5], v[32:33] op_sel_hi:[1,0,1]
    v_pk_fma_f32 v[18:19], v[18:19], v[4:5], v[34:35] op_sel_hi:[1,0,1]
    v_pk_fma_f32 v[20:21], v[20:21], v[4:5], v[36:37] op_sel_hi:[1,0,1]
    v_pk_fma_f32 v[22:23], v[22:23], v[4:5], v[38:39] op_sel_hi:[1,0,1]
    v_pk_fma_f32 v[24:25], v[24:25], v[4:5], v[40:41] op_sel_hi:[1,0,1]
    v_pk_fma_f32 v[26:27], v[26:27], v[4:5], v[42:43] op_sel_hi:[1,0,1]
    v_pk_fma_f32 v[28:29], v[28:29], v[4:5], v[44:45] op_sel_hi:[1,0,1]
    v_pk_fma_f32 v[30:31], v[30:31], v[4:5], v[46:47] op_sel_hi:[1,0,1]
    s_mov_b32 s70, 1280000
    s_lshl_b32 s65, s60, 2
    v_mov_b32 v98, s65
TW_66:
    ds_read_b32 v99, v98 offset:32
    s_waitcnt lgkmcnt(0)
    v_readfirstlane_b32 s71, v99
    s_nop 0
    s_cmp_ge_u32 s71, 8
    s_cbranch_scc1 TWD_67
    s_sub_u32 s70, s70, 1
    s_cbranch_scc0 TW_66
TWD_67:
    ds_read_b128 v[32:35], v1 offset:4096
    ds_read_b128 v[36:39], v1 offset:4352
    ds_read_b128 v[40:43], v1 offset:6144
    ds_read_b128 v[44:47], v1 offset:6400
    ds_read_b128 v[48:51], v1 offset:8192
    ds_read_b128 v[52:55], v1 offset:8448
    ds_read_b128 v[56:59], v1 offset:10240
    ds_read_b128 v[60:63], v1 offset:10496
    ds_read_b128 v[64:67], v1 offset:12288
    ds_read_b128 v[68:71], v1 offset:12544
    ds_read_b128 v[72:75], v1 offset:14336
    ds_read_b128 v[76:79], v1 offset:14592
    ds_read_b128 v[80:83], v1 offset:16384
    ds_read_b128 v[84:87], v1 offset:16640
    ds_read_b128 v[88:91], v1 offset:18432
    ds_read_b128 v[92:95], v1 offset:18688
    s_waitcnt lgkmcnt(11)
    v_pk_add_f32 v[32:33], v[32:33], v[48:49]
    v_pk_add_f32 v[34:35], v[34:35], v[50:51]
    s_waitcnt lgkmcnt(10)
    v_pk_add_f32 v[36:37], v[36:37], v[52:53]
    v_pk_add_f32 v[38:39], v[38:39], v[54:55]
    s_waitcnt lgkmcnt(9)
    v_pk_add_f32 v[40:41], v[40:41], v[56:57]
    v_pk_add_f32 v[42:43], v[42:43], v[58:59]
    s_waitcnt lgkmcnt(8)
    v_pk_add_f32 v[44:45], v[44:45], v[60:61]
    v_pk_add_f32 v[46:47], v[46:47], v[62:63]
    v_pk_add_f32 v[16:17], v[16:17], v[32:33]
    v_pk_add_f32 v[18:19], v[18:19], v[34:35]
    v_pk_add_f32 v[20:21], v[20:21], v[36:37]
    v_pk_add_f32 v[22:23], v[22:23], v[38:39]
    v_pk_add_f32 v[24:25], v[24:25], v[40:41]
    v_pk_add_f32 v[26:27], v[26:27], v[42:43]
    v_pk_add_f32 v[28:29], v[28:29], v[44:45]
    v_pk_add_f32 v[30:31], v[30:31], v[46:47]
    s_waitcnt lgkmcnt(7)
    v_pk_add_f32 v[16:17], v[16:17], v[64:65]
    v_pk_add_f32 v[18:19], v[18:19], v[66:67]
    s_waitcnt lgkmcnt(6)
    v_pk_add_f32 v[20:21], v[20:21], v[68:69]
    v_pk_add_f32 v[22:23], v[22:23], v[70:71]
    s_waitcnt lgkmcnt(5)
    v_pk_add_f32 v[24:25], v[24:25], v[72:73]
    v_pk_add_f32 v[26:27], v[26:27], v[74:75]
    s_waitcnt lgkmcnt(4)
    v_pk_add_f32 v[28:29], v[28:29], v[76:77]
    v_pk_add_f32 v[30:31], v[30:31], v[78:79]
    s_waitcnt lgkmcnt(3)
    v_pk_add_f32 v[16:17], v[16:17], v[80:81]
    v_pk_add_f32 v[18:19], v[18:19], v[82:83]
    s_waitcnt lgkmcnt(2)
    v_pk_add_f32 v[20:21], v[20:21], v[84:85]
    v_pk_add_f32 v[22:23], v[22:23], v[86:87]
    v_cvt_pk_bf16_f32 v120, v16, v17
    v_cvt_pk_bf16_f32 v121, v18, v19
    v_cvt_pk_bf16_f32 v122, v20, v21
    v_cvt_pk_bf16_f32 v123, v22, v23
    buffer_store_dwordx4 v[120:123], v5, s[48:51], 0 offen offset:0
    s_waitcnt lgkmcnt(1)
    v_pk_add_f32 v[24:25], v[24:25], v[88:89]
    v_pk_add_f32 v[26:27], v[26:27], v[90:91]
    s_waitcnt lgkmcnt(0)
    v_pk_add_f32 v[28:29], v[28:29], v[92:93]
    v_pk_add_f32 v[30:31], v[30:31], v[94:95]
    v_cvt_pk_bf16_f32 v124, v24, v25
    v_cvt_pk_bf16_f32 v125, v26, v27
    v_cvt_pk_bf16_f32 v126, v28, v29
    v_cvt_pk_bf16_f32 v127, v30, v31
    buffer_store_dwordx4 v[124:127], v5, s[48:51], 0 offen offset:64
L_END:
    s_endpgm
.section .rodata,"a"
.p2align 6
.amdhsa_kernel parallel_sum__linear_kernel_hedgehog__dense_activation_relu__prompt_kernel
  .amdhsa_next_free_vgpr 256
  .amdhsa_next_free_sgpr 102
  .amdhsa_accum_offset 256
  .amdhsa_group_segment_fixed_size 0
  .amdhsa_kernarg_size 80
  .amdhsa_user_sgpr_count 2
  .amdhsa_user_sgpr_kernarg_segment_ptr 1
  .amdhsa_system_sgpr_workgroup_id_x 1
  .amdhsa_float_denorm_mode_32 3
  .amdhsa_float_denorm_mode_16_64 3
.end_amdhsa_kernel
```
